```python
import torch

def _softmax(x, axis=-1):
    return torch.softmax(x, dim=axis)

def _gelu(x):
    return torch.nn.functional.gelu(x, approximate='tanh')

def _silu(x):
    return torch.nn.functional.silu(x)

def _sigmoid(x):
    return torch.sigmoid(x)

def _layernorm(x, axis=-1, eps=1e-05):
    m = x.mean(dim=axis, keepdim=True)
    v = x.var(dim=axis, keepdim=True, unbiased=False)
    return (x - m) / torch.sqrt(v + eps)

def _scatter_add(tgt, idx, src, axis=0):
    return tgt.clone().index_add_(axis, idx, src)

def _segment_sum(src, seg, n):
    out = torch.zeros((n,) + src.shape[1:], dtype=src.dtype)
    return out.index_add_(0, seg, src)

def _pad(x, pw):
    flat = tuple((v for pair in reversed(pw) for v in pair))
    return torch.nn.functional.pad(x, flat)
kernel_name = 'adaLN_cond__sliding_block_cached__dense_activation_silu__decode'

def setup_inputs():

    _w = lambda a: (lambda t: t.to(torch.bfloat16) if t.is_floating_point() else t)(torch.as_tensor(a))

    def _A_setup():
        B, Sq, D = (8, 1, 640)
        Hq, Hkv, Sk, Dh = (32, 32, 4096, 128)
        assert Hq % Hkv == 0, (Hq, Hkv)
        return {'x': _w((lambda *s: torch.randn(*s, dtype=torch.bfloat16) * 0.1)(B, Sq, D)), 'k_cache': _w((lambda *s: torch.randn(*s, dtype=torch.bfloat16) * 0.8)(B, Hkv, Sk, Dh)), 'v_cache': _w((lambda *s: torch.randn(*s, dtype=torch.bfloat16) * 3.2)(B, Hkv, Sk, Dh)), 'wq': _w((lambda *s: torch.randn(*s, dtype=torch.bfloat16) * 0.8)(D, Hq * Dh) * D ** (-0.5)), 'wo': _w((lambda *s: torch.randn(*s, dtype=torch.bfloat16) * 3.2)(Hq * Dh, D) * (Hq * Dh) ** (-0.5))}
    _A_in = _A_setup()

    def _B_setup():
        B, S, D, F = (8, 1, 640, 1728)
        return {'x': _w((lambda *s: torch.randn(*s, dtype=torch.bfloat16) * 0.1)(B, S, D)), 'w1': _w((lambda *s: torch.randn(*s, dtype=torch.bfloat16) * 3.2)(D, F) * D ** (-0.5)), 'w2': _w((lambda *s: torch.randn(*s, dtype=torch.bfloat16) * 3.2)(F, D) * F ** (-0.5))}
    _B_in = _B_setup()
    return {'A_x': _A_in['x'], 'A_k_cache': _A_in['k_cache'], 'A_v_cache': _A_in['v_cache'], 'A_wq': _A_in['wq'], 'A_wo': _A_in['wo'], 'B_x': _B_in['x'], 'B_w1': _B_in['w1'], 'B_w2': _B_in['w2'], 'c': _w((lambda *s: torch.randn(*s, dtype=torch.bfloat16) * 0.1)(8, 640) * 8.0), 'w_mod': _w((lambda *s: torch.randn(*s, dtype=torch.bfloat16) * 0.1)(640, 6 * 640) * 640 ** (-0.5) * 8.0)}

def reference(A_x, A_k_cache, A_v_cache, A_wq, A_wo, B_x, B_w1, B_w2, c, w_mod):

    def _A_ref(x, k_cache, v_cache, wq, wo):
        B, Sq, D = x.shape
        Hq, Dh = (32, 128)
        Hkv, Sk = (k_cache.shape[1], k_cache.shape[2])
        W = min(4096, max(256, Sk // 4))
        rep = Hq // Hkv
        q = (lambda x, *d: x.permute(*d))((x @ wq).reshape(B, Sq, Hq, Dh), 0, 2, 1, 3)
        k = (lambda x, n, axis: torch.repeat_interleave(x, n, dim=axis))(k_cache[:, :, Sk - W:, :], rep, axis=1)
        v = (lambda x, n, axis: torch.repeat_interleave(x, n, dim=axis))(v_cache[:, :, Sk - W:, :], rep, axis=1)
        scores = torch.einsum('bhqd,bhkd->bhqk', q, k) * Dh ** (-0.5)
        p = _softmax(scores, axis=-1)
        o = torch.einsum('bhqk,bhkd->bhqd', p, v)
        return (lambda x, *d: x.permute(*d))(o, 0, 2, 1, 3).reshape(B, Sq, Hq * Dh) @ wo

    def _B_ref(x, w1, w2):
        h = torch.einsum('bsd,df->bsf', x, w1)
        h = _silu(h)
        out = torch.einsum('bsf,fd->bsd', h, w2)
        return out
    x = A_x
    mod = (_silu(c) @ w_mod).reshape(c.shape[0], 6, 1, -1)
    sa, ca, ga, sb, cb, gb = (mod[:, 0].clone(), mod[:, 1].clone(), mod[:, 2].clone(), mod[:, 3].clone(), mod[:, 4].clone(), mod[:, 5].clone())
    h = _layernorm(x, axis=-1) * (1 + ca) + sa
    x = x + ga * _A_ref(h, A_k_cache, A_v_cache, A_wq, A_wo)
    h = _layernorm(x, axis=-1) * (1 + cb) + sb
    x = x + gb * _B_ref(h, B_w1, B_w2)
    return x
```

```asm
; @launch grid=(256,1,1) block=(512,1,1) lds=163840
.amdgcn_target "amdgcn-amd-amdhsa--gfx950"
.text
.globl adaLN_cond__sliding_block_cached__dense_activation_silu__decode_kernel
.p2align 8
.type adaLN_cond__sliding_block_cached__dense_activation_silu__decode_kernel,@function
adaLN_cond__sliding_block_cached__dense_activation_silu__decode_kernel:
  s_cmp_ge_u32 s2, 256
  s_cbranch_scc1 L_EXIT
  s_load_dwordx16 s[16:31], s[0:1], 0
  s_load_dwordx8 s[32:39], s[0:1], 64
  s_load_dwordx2 s[40:41], s[0:1], 96
  v_lshrrev_b32 v1, 6, v0
  v_and_b32 v0, 63, v0
  v_readfirstlane_b32 s3, v1
  s_lshr_b32 s4, s2, 5
  s_and_b32 s5, s2, 31
  s_and_b32 s96, s2, 7
  s_lshr_b32 s97, s2, 3
  s_sub_u32 s98, s2, s97
  s_add_u32 s8, s97, 256
  s_cmp_eq_u32 s96, 7
  s_cselect_b32 s98, s8, s98
  s_mov_b32 s60, 0
  s_sub_u32 s8, s98, 160
  s_cmp_lt_u32 s8, 60
  s_cselect_b32 s62, 1, 3
  s_cmp_lt_u32 s98, 128
  s_cselect_b32 s62, 0, s62
  s_sub_u32 s8, s98, 256
  s_cmp_lt_u32 s8, 27
  s_cselect_b32 s62, 2, s62
  s_cmp_ge_u32 s3, 4
  s_cbranch_scc1 L_STREAM
  s_setprio 2
  v_lshrrev_b32 v1, 4, v0
  v_and_b32 v2, 15, v0
  v_and_b32 v3, 7, v0
  v_lshlrev_b32 v10, 1, v1
  v_xor_b32 v10, v10, v3
  v_lshlrev_b32 v10, 4, v10
  v_lshrrev_b32 v11, 5, v0
  v_lshlrev_b32 v11, 3, v11
  v_bfe_u32 v6, v0, 3, 2
  v_add_u32 v11, v11, v6
  s_lshr_b32 s42, s98, 6
  s_and_b32 s43, s98, 63
  s_mul_i32 s8, s42, 320
  s_mov_b32 s9, s43
  s_cmp_lt_u32 s3, 2
  s_cselect_b32 s14, 3, 2
  s_movk_i32 s63, 8192
  s_cmp_eq_u32 s62, 0
  s_cbranch_scc1 L_EP
  s_mov_b32 s8, 0
  s_mov_b32 s14, 5
  s_sub_u32 s42, s98, 160
  s_cmp_eq_u32 s62, 1
  s_cselect_b32 s9, s42, s97
  s_movk_i32 s63, 3456
  s_cmovk_i32 s63, 7680
L_EP:
  v_mul_u32_u24 v12, s63, v11
  v_add_u32 v12, v12, v10
  s_lshl_b32 s10, s3, 5
  s_add_u32 s8, s8, s10
  s_mul_i32 s80, s8, s63
  s_lshl_b32 s9, s9, 7
  s_add_u32 s80, s80, s9
  s_lshl_b32 s8, s63, 4
  s_add_u32 s81, s80, s8
  s_lshl_b32 s8, s63, 2
  s_add_u32 s82, s80, s8
  s_add_u32 s83, s81, s8
  s_sub_u32 s81, s81, 1024
  s_sub_u32 s82, s82, 2048
  s_sub_u32 s83, s83, 3072
  s_lshl_b32 s13, s63, 7
  s_lshl_b32 s8, s3, 12
  s_add_u32 m0, s8, 16384
  s_mul_i32 s58, s63, 640
  s_mov_b32 s59, 0x20000
  s_waitcnt lgkmcnt(0)
  s_cmp_eq_u32 s62, 1
  s_cselect_b64 s[56:57], s[34:35], s[28:29]
  s_cmp_eq_u32 s62, 0
  s_cselect_b64 s[56:57], s[22:23], s[56:57]
  s_cmp_eq_u32 s62, 3
  s_cbranch_scc1 L_E1
  buffer_load_dwordx4 v12, s[56:59], s80 offen offset:0 nt lds
  buffer_load_dwordx4 v12, s[56:59], s81 offen offset:1024 nt lds
  buffer_load_dwordx4 v12, s[56:59], s82 offen offset:2048 nt lds
  buffer_load_dwordx4 v12, s[56:59], s83 offen offset:3072 nt lds
L_E1:
  s_mov_b32 s52, s40
  s_mov_b32 s53, s41
  s_mov_b32 s54, 4194304
  s_mov_b32 s55, 0x20000
  s_buffer_load_dword s12, s[52:55], 0x0
  v_mov_b32 v4, 0
  v_mov_b32 v5, 1
  s_mov_b32 s15, 0
  s_getpc_b64 s[72:73]
L_PC:
  s_sub_u32 s72, s72, L_PC-adaLN_cond__sliding_block_cached__dense_activation_silu__decode_kernel
  s_subb_u32 s73, s73, 0
  s_lshl_b32 s8, s97, 2
  s_add_u32 s8, s8, s3
  s_lshl_b32 s8, s8, 8
  s_min_u32 s8, s8, L_EXIT-adaLN_cond__sliding_block_cached__dense_activation_silu__decode_kernel-128
  s_load_dword s74, s[72:73], s8
  s_load_dword s75, s[72:73], s8 offset:128
  s_cmp_eq_u32 s62, 3
  s_cbranch_scc1 L_E3
  s_cmp_lg_u32 s62, 1
  s_cbranch_scc1 L_E2n
  s_mov_b32 s64, s32
  s_mov_b32 s65, s33
  s_mov_b32 s66, 10240
  s_mov_b32 s67, 0x20000
  s_mov_b32 s68, s16
  s_mov_b32 s69, s17
  s_mov_b32 s70, 10240
  s_mov_b32 s71, 0x20000
  v_lshlrev_b32 v6, 3, v0
  s_mul_i32 s8, s3, 2560
  buffer_load_dwordx2 v[20:21], v6, s[64:67], s8 offen offset:0
  buffer_load_dwordx2 v[22:23], v6, s[64:67], s8 offen offset:512
  buffer_load_dwordx2 v[24:25], v6, s[64:67], s8 offen offset:1024
  buffer_load_dwordx2 v[26:27], v6, s[64:67], s8 offen offset:1536
  buffer_load_dwordx2 v[28:29], v6, s[64:67], s8 offen offset:2048
  s_sub_u32 s43, s42, 10
  s_cmp_ge_u32 s43, 10
  s_cbranch_scc1 L_E2n
  v_lshrrev_b32 v6, 5, v0
  v_mul_u32_u24 v6, 1280, v6
  v_and_b32 v7, 31, v0
  v_lshl_add_u32 v6, v7, 3, v6
  buffer_load_dwordx2 v[96:97], v6, s[68:71], s8 offen offset:0
  buffer_load_dwordx2 v[98:99], v6, s[68:71], s8 offen offset:256
  buffer_load_dwordx2 v[100:101], v6, s[68:71], s8 offen offset:512
  buffer_load_dwordx2 v[102:103], v6, s[68:71], s8 offen offset:768
  buffer_load_dwordx2 v[104:105], v6, s[68:71], s8 offen offset:1024
  v_mul_u32_u24 v6, 1280, v3
  v_lshl_add_u32 v6, v1, 3, v6
  s_lshl_b32 s9, s43, 7
  s_lshl_b32 s10, s3, 5
  s_add_u32 s9, s9, s10
  buffer_load_dwordx2 v[56:57], v6, s[68:71], s9 offen
  s_branch L_E2n
L_E2:
  s_sub_u32 s8, s98, 160
  s_cmp_lt_u32 s8, 20
  s_cbranch_scc1 E2_1
  s_waitcnt vmcnt(4)
E2_1:
  s_waitcnt vmcnt(7)
  buffer_load_dwordx4 v12, s[56:59], s80 offen offset:0 nt lds
  s_cbranch_scc1 E2_2
  s_waitcnt vmcnt(4)
E2_2:
  s_waitcnt vmcnt(7)
  buffer_load_dwordx4 v12, s[56:59], s81 offen offset:1024 nt lds
  s_cbranch_scc1 E2_3
  s_waitcnt vmcnt(4)
E2_3:
  s_waitcnt vmcnt(7)
  buffer_load_dwordx4 v12, s[56:59], s82 offen offset:2048 nt lds
  s_cbranch_scc1 E2_4
  s_waitcnt vmcnt(4)
E2_4:
  s_waitcnt vmcnt(7)
  buffer_load_dwordx4 v12, s[56:59], s83 offen offset:3072 nt lds
L_E2n:
  s_add_u32 m0, m0, 16384
  s_add_u32 s80, s80, s13
  s_add_u32 s81, s81, s13
  s_add_u32 s82, s82, s13
  s_add_u32 s83, s83, s13
  s_sub_u32 s14, s14, 1
  s_cmp_lg_u32 s14, 0
  s_cbranch_scc1 L_E2
L_E3:
  s_cmp_lg_u32 s3, 0
  s_cbranch_scc1 IB_5
  v_lshlrev_b32 v6, 2, v0
  s_mov_b32 exec_hi, 0
  ds_write_b32 v6, v4
  s_mov_b64 exec, -1
IB_5:
  s_waitcnt lgkmcnt(0)
  s_barrier
  v_lshrrev_b32 v6, 2, v2
  v_lshl_add_u32 v8, v1, 2, v6
  v_bfe_u32 v7, v8, 1, 2
  s_and_b32 s8, s3, 3
  v_xor_b32 v7, s8, v7
  v_lshlrev_b32 v8, 7, v8
  v_lshl_add_u32 v8, v7, 5, v8
  v_and_b32 v6, 3, v0
  v_lshl_add_u32 v8, v6, 3, v8
  v_add_u32 v14, 0x10000, v8
  v_mul_u32_u24 v9, 144, v1
  v_lshl_add_u32 v9, v3, 4, v9
  s_waitcnt lgkmcnt(0)
  s_add_u32 s12, s12, 1
  s_mul_i32 s6, s12, 0x9E3779B1
  s_movk_i32 s101, 0xff
  s_and_b32 s99, s12, s101
  s_xor_b32 s1, s99, 0x55
  v_mov_b32 v15, s99
  s_lshl_b32 s8, s3, 8
  s_add_u32 s8, s8, s2
  s_sub_u32 s8, s8, 512
  s_cmp_ge_u32 s8, 10
  s_cbranch_scc1 CL_6
  v_mov_b32 v16, 0xffbfffbf
  v_mov_b32 v17, 0xffbfffbf
  v_mov_b32 v18, 0xffbfffbf
  v_mov_b32 v19, 0xffbfffbf
  v_lshlrev_b32 v6, 4, v0
  s_lshl_b32 s8, s8, 10
  s_add_u32 s8, s8, 98304
  buffer_store_dwordx4 v[16:19], v6, s[52:55], s8 offen sc1
CL_6:
  s_cmp_eq_u32 s62, 0
  s_cbranch_scc1 L_RQ
  s_cmp_eq_u32 s62, 1
  s_cbranch_scc1 L_RMOD
  s_cmp_eq_u32 s62, 2
  s_cbranch_scc1 L_RMLP
  s_branch L_RNONE
L_STREAM:
  s_lshl_b32 s8, s2, 20
  s_add_u32 s8, s8, 0xC0000
  s_lshl_b32 s9, s3, 12
  s_sub_u32 s9, s9, 16384
  v_lshlrev_b32 v1, 4, v0
  s_movk_i32 s11, 0x4000
  s_movk_i32 s12, 0x1000
  s_mul_i32 s10, s97, 8192
  s_add_u32 s10, s10, s9
  s_mov_b32 s14, 0x3ffff
  s_and_b32 s10, s10, s14
  s_mov_b32 s46, 0x40000
  s_mov_b32 s47, 0x20000
  s_mov_b32 s50, 0x40000
  s_mov_b32 s51, 0x20000
  v_mov_b32 v4, 0
  v_mov_b32 v5, 1
  s_cmp_eq_u32 s62, 1
  s_cselect_b32 s94, 1, 2
  s_cmp_eq_u32 s62, 2
  s_cselect_b32 s94, 0, s94
  s_waitcnt lgkmcnt(0)
  s_add_u32 s44, s18, s8
  s_addc_u32 s45, s19, 0
  buffer_load_dwordx4 v[48:51], v1, s[44:47], s10 offen offset:0 nt
  s_add_u32 s48, s20, s8
  s_addc_u32 s49, s21, 0
  s_mov_b32 s52, s40
  s_mov_b32 s53, s41
  s_mov_b32 s54, 4194304
  s_mov_b32 s55, 0x20000
  s_mul_i32 s8, s9, 7
  s_add_u32 s8, s8, 49152
  s_mov_b32 m0, s8
  v_add_u32 v7, s8, v1
  v_and_b32 v2, 15, v0
  v_and_b32 v3, 1, v0
  v_lshlrev_b32 v3, 4, v3
  v_mov_b32 v6, 0xffff
  v_lshlrev_b32 v6, v3, v6
  v_lshrrev_b32 v3, 1, v2
  v_cmp_eq_u32 vcc, 0, v3
  s_nop 1
  v_cndmask_b32 v8, 0, v6, vcc
  v_cmp_eq_u32 vcc, 1, v3
  s_nop 1
  v_cndmask_b32 v9, 0, v6, vcc
  v_cmp_eq_u32 vcc, 2, v3
  s_nop 1
  v_cndmask_b32 v10, 0, v6, vcc
  v_cmp_eq_u32 vcc, 3, v3
  s_nop 1
  v_cndmask_b32 v11, 0, v6, vcc
  v_lshlrev_b32 v2, 4, v2
  s_cmp_eq_u32 s62, 3
  s_cbranch_scc1 L_PA3
  s_barrier
  s_cmp_eq_u32 s62, 1
  s_cbranch_scc1 L_PA1
  s_cmp_eq_u32 s62, 2
  s_cbranch_scc1 L_PA2
L_PA0:
  buffer_load_dwordx4 v[52:55], v1, s[44:47], s10 offen offset:1024 nt
  buffer_load_dwordx4 v[56:59], v1, s[44:47], s10 offen offset:2048 nt
  buffer_load_dwordx4 v[60:63], v1, s[44:47], s10 offen offset:3072 nt
  s_add_u32 s10, s10, s11
  s_and_b32 s10, s10, s14
  buffer_load_dwordx4 v[64:67], v1, s[44:47], s10 offen offset:0 nt
  s_waitcnt vmcnt(4)
  buffer_load_dwordx4 v[68:71], v1, s[44:47], s10 offen offset:1024 nt
  s_waitcnt vmcnt(4)
  buffer_load_dwordx4 v[72:75], v1, s[44:47], s10 offen offset:2048 nt
  s_waitcnt vmcnt(4)
  buffer_load_dwordx4 v[76:79], v1, s[44:47], s10 offen offset:3072 nt
  s_add_u32 s10, s10, s11
  s_and_b32 s10, s10, s14
  s_waitcnt vmcnt(4)
  buffer_load_dwordx4 v[80:83], v1, s[44:47], s10 offen offset:0 nt
  s_waitcnt vmcnt(4)
  buffer_load_dwordx4 v[84:87], v1, s[44:47], s10 offen offset:1024 nt
  s_waitcnt vmcnt(4)
  buffer_load_dwordx4 v[88:91], v1, s[44:47], s10 offen offset:2048 nt
  s_waitcnt vmcnt(4)
  buffer_load_dwordx4 v[92:95], v1, s[44:47], s10 offen offset:3072 nt
  s_add_u32 s10, s10, s11
  s_and_b32 s10, s10, s14
  s_waitcnt vmcnt(4)
  buffer_load_dwordx4 v[96:99], v1, s[44:47], s10 offen offset:0 nt
  s_waitcnt vmcnt(4)
  buffer_load_dwordx4 v[100:103], v1, s[44:47], s10 offen offset:1024 nt
  s_waitcnt vmcnt(4)
  buffer_load_dwordx4 v[104:107], v1, s[44:47], s10 offen offset:2048 nt
  s_waitcnt vmcnt(4)
  buffer_load_dwordx4 v[108:111], v1, s[44:47], s10 offen offset:3072 nt
  s_add_u32 s10, s10, s11
  s_and_b32 s10, s10, s14
  s_waitcnt vmcnt(4)
  buffer_load_dwordx4 v[112:115], v1, s[44:47], s10 offen offset:0 nt
  s_waitcnt vmcnt(4)
  buffer_load_dwordx4 v[116:119], v1, s[44:47], s10 offen offset:1024 nt
  s_waitcnt vmcnt(4)
  buffer_load_dwordx4 v[120:123], v1, s[44:47], s10 offen offset:2048 nt
  s_waitcnt vmcnt(4)
  buffer_load_dwordx4 v[124:127], v1, s[44:47], s10 offen offset:3072 nt
  s_add_u32 s10, s10, s11
  s_and_b32 s10, s10, s14
  s_waitcnt vmcnt(4)
  buffer_load_dwordx4 v[128:131], v1, s[44:47], s10 offen offset:0 nt
  s_waitcnt vmcnt(4)
  buffer_load_dwordx4 v[132:135], v1, s[44:47], s10 offen offset:1024 nt
  s_waitcnt vmcnt(4)
  buffer_load_dwordx4 v[136:139], v1, s[44:47], s10 offen offset:2048 nt
  s_waitcnt vmcnt(4)
  buffer_load_dwordx4 v[140:143], v1, s[44:47], s10 offen offset:3072 nt
  s_add_u32 s10, s10, s11
  s_and_b32 s10, s10, s14
  s_waitcnt vmcnt(4)
  buffer_load_dwordx4 v[144:147], v1, s[44:47], s10 offen offset:0 nt
  s_mov_b64 exec, 1
  ds_add_u32 v4, v5 offset:44
  s_mov_b64 exec, -1
  s_waitcnt vmcnt(4)
  buffer_load_dwordx4 v[148:151], v1, s[44:47], s10 offen offset:1024 nt
  s_waitcnt vmcnt(4)
  buffer_load_dwordx4 v[152:155], v1, s[44:47], s10 offen offset:2048 nt
  s_waitcnt vmcnt(4)
  buffer_load_dwordx4 v[156:159], v1, s[44:47], s10 offen offset:3072 nt
  s_add_u32 s10, s10, s11
  s_and_b32 s10, s10, s14
  s_waitcnt vmcnt(4)
  buffer_load_dwordx4 v[160:163], v1, s[44:47], s10 offen offset:0 nt
  s_waitcnt vmcnt(4)
  buffer_load_dwordx4 v[164:167], v1, s[44:47], s10 offen offset:1024 nt
  s_waitcnt vmcnt(4)
  buffer_load_dwordx4 v[168:171], v1, s[44:47], s10 offen offset:2048 nt
  s_waitcnt vmcnt(4)
  buffer_load_dwordx4 v[172:175], v1, s[44:47], s10 offen offset:3072 nt
  s_add_u32 s10, s10, s11
  s_and_b32 s10, s10, s14
  s_waitcnt vmcnt(4)
  buffer_load_dwordx4 v[176:179], v1, s[44:47], s10 offen offset:0 nt
  s_waitcnt vmcnt(4)
  buffer_load_dwordx4 v[180:183], v1, s[44:47], s10 offen offset:1024 nt
  s_waitcnt vmcnt(4)
  buffer_load_dwordx4 v[184:187], v1, s[44:47], s10 offen offset:2048 nt
  s_waitcnt vmcnt(4)
  buffer_load_dwordx4 v[188:191], v1, s[44:47], s10 offen offset:3072 nt
  s_add_u32 s10, s10, s11
  s_and_b32 s10, s10, s14
  s_waitcnt vmcnt(4)
  buffer_load_dwordx4 v[192:195], v1, s[44:47], s10 offen offset:0 nt
  s_waitcnt vmcnt(4)
  buffer_load_dwordx4 v[196:199], v1, s[44:47], s10 offen offset:1024 nt
  s_waitcnt vmcnt(4)
  buffer_load_dwordx4 v[200:203], v1, s[44:47], s10 offen offset:2048 nt
  s_waitcnt vmcnt(4)
  buffer_load_dwordx4 v[204:207], v1, s[44:47], s10 offen offset:3072 nt
  s_add_u32 s10, s10, s11
  s_and_b32 s10, s10, s14
  s_waitcnt vmcnt(4)
  buffer_load_dwordx4 v[208:211], v1, s[44:47], s10 offen offset:0 nt
  s_waitcnt vmcnt(4)
  buffer_load_dwordx4 v[212:215], v1, s[44:47], s10 offen offset:1024 nt
  s_waitcnt vmcnt(4)
  buffer_load_dwordx4 v[216:219], v1, s[44:47], s10 offen offset:2048 nt
  s_waitcnt vmcnt(4)
  buffer_load_dwordx4 v[220:223], v1, s[44:47], s10 offen offset:3072 nt
  s_add_u32 s10, s10, s11
  s_and_b32 s10, s10, s14
  s_waitcnt vmcnt(4)
  buffer_load_dwordx4 v[224:227], v1, s[44:47], s10 offen offset:0 nt
  s_mov_b64 exec, 1
  ds_add_u32 v4, v5 offset:28
  s_mov_b64 exec, -1
  s_waitcnt vmcnt(4)
  buffer_load_dwordx4 v[228:231], v1, s[44:47], s10 offen offset:1024 nt
  s_waitcnt vmcnt(4)
  buffer_load_dwordx4 v[232:235], v1, s[44:47], s10 offen offset:2048 nt
  s_waitcnt vmcnt(4)
  buffer_load_dwordx4 v[236:239], v1, s[44:47], s10 offen offset:3072 nt
  s_add_u32 s10, s10, s11
  s_and_b32 s10, s10, s14
  s_mov_b32 s7, 1048576
LW_7:
  ds_read_b32 v6, v4 offset:16
  s_waitcnt lgkmcnt(0)
  v_cmp_le_u32 vcc, 4, v6
  s_cbranch_vccnz LWd_8
  s_sub_u32 s7, s7, 1
  s_cbranch_scc0 LW_7
  s_branch L_END
LWd_8:
  s_waitcnt vmcnt(4)
  buffer_load_dwordx4 v1, s[44:47], s10 offen offset:0 nt lds
  s_waitcnt vmcnt(4)
  buffer_load_dwordx4 v1, s[44:47], s10 offen offset:1024 nt lds
  s_waitcnt vmcnt(4)
  buffer_load_dwordx4 v1, s[44:47], s10 offen offset:2048 nt lds
  s_waitcnt vmcnt(4)
  buffer_load_dwordx4 v1, s[44:47], s10 offen offset:3072 nt lds
  s_add_u32 m0, m0, s12
  s_add_u32 s10, s10, s11
  s_and_b32 s10, s10, s14
  s_waitcnt vmcnt(4)
  buffer_load_dwordx4 v1, s[44:47], s10 offen offset:0 nt lds
  s_mov_b64 exec, 1
  ds_add_u32 v4, v5 offset:64
  s_mov_b64 exec, -1
  s_waitcnt vmcnt(4)
  buffer_load_dwordx4 v1, s[44:47], s10 offen offset:1024 nt lds
  s_waitcnt vmcnt(4)
  buffer_load_dwordx4 v1, s[44:47], s10 offen offset:2048 nt lds
  s_waitcnt vmcnt(4)
  buffer_load_dwordx4 v1, s[44:47], s10 offen offset:3072 nt lds
  s_add_u32 m0, m0, s12
  s_add_u32 s10, s10, s11
  s_and_b32 s10, s10, s14
  s_waitcnt vmcnt(4)
  buffer_load_dwordx4 v1, s[44:47], s10 offen offset:0 nt lds
  s_waitcnt vmcnt(4)
  buffer_load_dwordx4 v1, s[44:47], s10 offen offset:1024 nt lds
  s_waitcnt vmcnt(4)
  buffer_load_dwordx4 v1, s[44:47], s10 offen offset:2048 nt lds
  s_waitcnt vmcnt(4)
  buffer_load_dwordx4 v1, s[44:47], s10 offen offset:3072 nt lds
  s_add_u32 m0, m0, s12
  s_add_u32 s10, s10, s11
  s_and_b32 s10, s10, s14
  s_waitcnt vmcnt(4)
  buffer_load_dwordx4 v1, s[44:47], s10 offen offset:0 nt lds
  s_waitcnt vmcnt(5)
  buffer_load_dwordx4 v1, s[44:47], s10 offen offset:1024 nt lds
  s_waitcnt vmcnt(4)
  buffer_load_dwordx4 v1, s[44:47], s10 offen offset:2048 nt lds
  s_waitcnt vmcnt(5)
  buffer_load_dwordx4 v1, s[44:47], s10 offen offset:3072 nt lds
  s_add_u32 m0, m0, s12
  s_add_u32 s10, s10, s11
  s_and_b32 s10, s10, s14
  s_waitcnt vmcnt(4)
  buffer_load_dwordx4 v1, s[48:51], s10 offen offset:0 nt lds
  s_waitcnt vmcnt(5)
  buffer_load_dwordx4 v1, s[48:51], s10 offen offset:1024 nt lds
  s_waitcnt vmcnt(4)
  buffer_load_dwordx4 v1, s[48:51], s10 offen offset:2048 nt lds
  s_waitcnt vmcnt(5)
  buffer_load_dwordx4 v1, s[48:51], s10 offen offset:3072 nt lds
  s_add_u32 m0, m0, s12
  s_add_u32 s10, s10, s11
  s_and_b32 s10, s10, s14
  s_waitcnt vmcnt(4)
  buffer_load_dwordx4 v1, s[48:51], s10 offen offset:0 nt lds
  s_waitcnt vmcnt(5)
  buffer_load_dwordx4 v1, s[48:51], s10 offen offset:1024 nt lds
  s_waitcnt vmcnt(4)
  buffer_load_dwordx4 v1, s[48:51], s10 offen offset:2048 nt lds
  s_waitcnt vmcnt(5)
  buffer_load_dwordx4 v1, s[48:51], s10 offen offset:3072 nt lds
  s_add_u32 m0, m0, s12
  s_add_u32 s10, s10, s11
  s_and_b32 s10, s10, s14
  s_waitcnt vmcnt(4)
  buffer_load_dwordx4 v1, s[48:51], s10 offen offset:0 nt lds
  s_mov_b64 exec, 1
  ds_add_u32 v4, v5 offset:32
  s_mov_b64 exec, -1
  s_waitcnt vmcnt(5)
  buffer_load_dwordx4 v1, s[48:51], s10 offen offset:1024 nt lds
  s_waitcnt vmcnt(4)
  buffer_load_dwordx4 v1, s[48:51], s10 offen offset:2048 nt lds
  s_waitcnt vmcnt(5)
  buffer_load_dwordx4 v1, s[48:51], s10 offen offset:3072 nt lds
  s_add_u32 m0, m0, s12
  s_add_u32 s10, s10, s11
  s_and_b32 s10, s10, s14
  s_mov_b32 s92, 0x1122
  s_branch L_PB
L_PA3:
  buffer_load_dwordx4 v[52:55], v1, s[44:47], s10 offen offset:1024 nt
  buffer_load_dwordx4 v[56:59], v1, s[44:47], s10 offen offset:2048 nt
  buffer_load_dwordx4 v[60:63], v1, s[44:47], s10 offen offset:3072 nt
  s_add_u32 s10, s10, s11
  s_and_b32 s10, s10, s14
  buffer_load_dwordx4 v[64:67], v1, s[44:47], s10 offen offset:0 nt
  s_waitcnt vmcnt(4)
  buffer_load_dwordx4 v[68:71], v1, s[44:47], s10 offen offset:1024 nt
  s_waitcnt vmcnt(4)
  buffer_load_dwordx4 v[72:75], v1, s[44:47], s10 offen offset:2048 nt
  s_waitcnt vmcnt(4)
  buffer_load_dwordx4 v[76:79], v1, s[44:47], s10 offen offset:3072 nt
  s_add_u32 s10, s10, s11
  s_and_b32 s10, s10, s14
  s_waitcnt vmcnt(4)
  buffer_load_dwordx4 v[80:83], v1, s[44:47], s10 offen offset:0 nt
  s_waitcnt vmcnt(4)
  buffer_load_dwordx4 v[84:87], v1, s[44:47], s10 offen offset:1024 nt
  s_barrier
  s_waitcnt vmcnt(4)
  buffer_load_dwordx4 v[88:91], v1, s[44:47], s10 offen offset:2048 nt
  s_waitcnt vmcnt(4)
  buffer_load_dwordx4 v[92:95], v1, s[44:47], s10 offen offset:3072 nt
  s_add_u32 s10, s10, s11
  s_and_b32 s10, s10, s14
  s_waitcnt vmcnt(4)
  buffer_load_dwordx4 v[96:99], v1, s[44:47], s10 offen offset:0 nt
  s_waitcnt vmcnt(4)
  buffer_load_dwordx4 v[100:103], v1, s[44:47], s10 offen offset:1024 nt
  s_waitcnt vmcnt(4)
  buffer_load_dwordx4 v[104:107], v1, s[44:47], s10 offen offset:2048 nt
  s_waitcnt vmcnt(4)
  buffer_load_dwordx4 v[108:111], v1, s[44:47], s10 offen offset:3072 nt
  s_add_u32 s10, s10, s11
  s_and_b32 s10, s10, s14
  s_waitcnt vmcnt(4)
  buffer_load_dwordx4 v[112:115], v1, s[44:47], s10 offen offset:0 nt
  s_waitcnt vmcnt(4)
  buffer_load_dwordx4 v[116:119], v1, s[44:47], s10 offen offset:1024 nt
  s_waitcnt vmcnt(4)
  buffer_load_dwordx4 v[120:123], v1, s[44:47], s10 offen offset:2048 nt
  s_waitcnt vmcnt(4)
  buffer_load_dwordx4 v[124:127], v1, s[44:47], s10 offen offset:3072 nt
  s_add_u32 s10, s10, s11
  s_and_b32 s10, s10, s14
  s_waitcnt vmcnt(4)
  buffer_load_dwordx4 v[128:131], v1, s[44:47], s10 offen offset:0 nt
  s_waitcnt vmcnt(4)
  buffer_load_dwordx4 v[132:135], v1, s[44:47], s10 offen offset:1024 nt
  s_waitcnt vmcnt(4)
  buffer_load_dwordx4 v[136:139], v1, s[44:47], s10 offen offset:2048 nt
  s_waitcnt vmcnt(4)
  buffer_load_dwordx4 v[140:143], v1, s[44:47], s10 offen offset:3072 nt
  s_add_u32 s10, s10, s11
  s_and_b32 s10, s10, s14
  s_waitcnt vmcnt(4)
  buffer_load_dwordx4 v[144:147], v1, s[44:47], s10 offen offset:0 nt
  s_mov_b64 exec, 1
  ds_add_u32 v4, v5 offset:44
  s_mov_b64 exec, -1
  s_waitcnt vmcnt(4)
  buffer_load_dwordx4 v[148:151], v1, s[44:47], s10 offen offset:1024 nt
  s_waitcnt vmcnt(4)
  buffer_load_dwordx4 v[152:155], v1, s[44:47], s10 offen offset:2048 nt
  s_waitcnt vmcnt(4)
  buffer_load_dwordx4 v[156:159], v1, s[44:47], s10 offen offset:3072 nt
  s_add_u32 s10, s10, s11
  s_and_b32 s10, s10, s14
  s_waitcnt vmcnt(4)
  buffer_load_dwordx4 v[160:163], v1, s[44:47], s10 offen offset:0 nt
  s_waitcnt vmcnt(4)
  buffer_load_dwordx4 v[164:167], v1, s[44:47], s10 offen offset:1024 nt
  s_waitcnt vmcnt(4)
  buffer_load_dwordx4 v[168:171], v1, s[44:47], s10 offen offset:2048 nt
  s_waitcnt vmcnt(4)
  buffer_load_dwordx4 v[172:175], v1, s[44:47], s10 offen offset:3072 nt
  s_add_u32 s10, s10, s11
  s_and_b32 s10, s10, s14
  s_waitcnt vmcnt(4)
  buffer_load_dwordx4 v[176:179], v1, s[44:47], s10 offen offset:0 nt
  s_waitcnt vmcnt(4)
  buffer_load_dwordx4 v[180:183], v1, s[44:47], s10 offen offset:1024 nt
  s_waitcnt vmcnt(4)
  buffer_load_dwordx4 v[184:187], v1, s[44:47], s10 offen offset:2048 nt
  s_waitcnt vmcnt(4)
  buffer_load_dwordx4 v[188:191], v1, s[44:47], s10 offen offset:3072 nt
  s_add_u32 s10, s10, s11
  s_and_b32 s10, s10, s14
  s_waitcnt vmcnt(4)
  buffer_load_dwordx4 v[192:195], v1, s[44:47], s10 offen offset:0 nt
  s_waitcnt vmcnt(4)
  buffer_load_dwordx4 v[196:199], v1, s[44:47], s10 offen offset:1024 nt
  s_waitcnt vmcnt(4)
  buffer_load_dwordx4 v[200:203], v1, s[44:47], s10 offen offset:2048 nt
  s_waitcnt vmcnt(4)
  buffer_load_dwordx4 v[204:207], v1, s[44:47], s10 offen offset:3072 nt
  s_add_u32 s10, s10, s11
  s_and_b32 s10, s10, s14
  s_waitcnt vmcnt(4)
  buffer_load_dwordx4 v[208:211], v1, s[44:47], s10 offen offset:0 nt
  s_waitcnt vmcnt(4)
  buffer_load_dwordx4 v[212:215], v1, s[44:47], s10 offen offset:1024 nt
  s_waitcnt vmcnt(4)
  buffer_load_dwordx4 v[216:219], v1, s[44:47], s10 offen offset:2048 nt
  s_waitcnt vmcnt(4)
  buffer_load_dwordx4 v[220:223], v1, s[44:47], s10 offen offset:3072 nt
  s_add_u32 s10, s10, s11
  s_and_b32 s10, s10, s14
  s_waitcnt vmcnt(4)
  buffer_load_dwordx4 v[224:227], v1, s[44:47], s10 offen offset:0 nt
  s_mov_b64 exec, 1
  ds_add_u32 v4, v5 offset:28
  s_mov_b64 exec, -1
  s_waitcnt vmcnt(4)
  buffer_load_dwordx4 v[228:231], v1, s[44:47], s10 offen offset:1024 nt
  s_waitcnt vmcnt(4)
  buffer_load_dwordx4 v[232:235], v1, s[44:47], s10 offen offset:2048 nt
  s_waitcnt vmcnt(4)
  buffer_load_dwordx4 v[236:239], v1, s[44:47], s10 offen offset:3072 nt
  s_add_u32 s10, s10, s11
  s_and_b32 s10, s10, s14
  s_mov_b32 s7, 1048576
LW_9:
  ds_read_b32 v6, v4 offset:16
  s_waitcnt lgkmcnt(0)
  v_cmp_le_u32 vcc, 4, v6
  s_cbranch_vccnz LWd_10
  s_sub_u32 s7, s7, 1
  s_cbranch_scc0 LW_9
  s_branch L_END
LWd_10:
  s_waitcnt vmcnt(4)
  buffer_load_dwordx4 v1, s[44:47], s10 offen offset:0 nt lds
  s_waitcnt vmcnt(4)
  buffer_load_dwordx4 v1, s[44:47], s10 offen offset:1024 nt lds
  s_waitcnt vmcnt(4)
  buffer_load_dwordx4 v1, s[44:47], s10 offen offset:2048 nt lds
  s_waitcnt vmcnt(4)
  buffer_load_dwordx4 v1, s[44:47], s10 offen offset:3072 nt lds
  s_add_u32 m0, m0, s12
  s_add_u32 s10, s10, s11
  s_and_b32 s10, s10, s14
  s_waitcnt vmcnt(4)
  buffer_load_dwordx4 v1, s[44:47], s10 offen offset:0 nt lds
  s_mov_b64 exec, 1
  ds_add_u32 v4, v5 offset:64
  s_mov_b64 exec, -1
  s_waitcnt vmcnt(4)
  buffer_load_dwordx4 v1, s[44:47], s10 offen offset:1024 nt lds
  s_waitcnt vmcnt(4)
  buffer_load_dwordx4 v1, s[44:47], s10 offen offset:2048 nt lds
  s_waitcnt vmcnt(4)
  buffer_load_dwordx4 v1, s[44:47], s10 offen offset:3072 nt lds
  s_add_u32 m0, m0, s12
  s_add_u32 s10, s10, s11
  s_and_b32 s10, s10, s14
  s_waitcnt vmcnt(4)
  buffer_load_dwordx4 v1, s[44:47], s10 offen offset:0 nt lds
  s_waitcnt vmcnt(4)
  buffer_load_dwordx4 v1, s[44:47], s10 offen offset:1024 nt lds
  s_waitcnt vmcnt(4)
  buffer_load_dwordx4 v1, s[44:47], s10 offen offset:2048 nt lds
  s_waitcnt vmcnt(4)
  buffer_load_dwordx4 v1, s[44:47], s10 offen offset:3072 nt lds
  s_add_u32 m0, m0, s12
  s_add_u32 s10, s10, s11
  s_and_b32 s10, s10, s14
  s_waitcnt vmcnt(4)
  buffer_load_dwordx4 v1, s[44:47], s10 offen offset:0 nt lds
  s_waitcnt vmcnt(4)
  buffer_load_dwordx4 v1, s[44:47], s10 offen offset:1024 nt lds
  s_waitcnt vmcnt(4)
  buffer_load_dwordx4 v1, s[44:47], s10 offen offset:2048 nt lds
  s_waitcnt vmcnt(4)
  buffer_load_dwordx4 v1, s[44:47], s10 offen offset:3072 nt lds
  s_add_u32 m0, m0, s12
  s_add_u32 s10, s10, s11
  s_and_b32 s10, s10, s14
  s_waitcnt vmcnt(4)
  buffer_load_dwordx4 v1, s[48:51], s10 offen offset:0 nt lds
  s_waitcnt vmcnt(4)
  buffer_load_dwordx4 v1, s[48:51], s10 offen offset:1024 nt lds
  s_waitcnt vmcnt(4)
  buffer_load_dwordx4 v1, s[48:51], s10 offen offset:2048 nt lds
  s_waitcnt vmcnt(4)
  buffer_load_dwordx4 v1, s[48:51], s10 offen offset:3072 nt lds
  s_add_u32 m0, m0, s12
  s_add_u32 s10, s10, s11
  s_and_b32 s10, s10, s14
  s_waitcnt vmcnt(4)
  buffer_load_dwordx4 v1, s[48:51], s10 offen offset:0 nt lds
  s_waitcnt vmcnt(4)
  buffer_load_dwordx4 v1, s[48:51], s10 offen offset:1024 nt lds
  s_waitcnt vmcnt(4)
  buffer_load_dwordx4 v1, s[48:51], s10 offen offset:2048 nt lds
  s_waitcnt vmcnt(4)
  buffer_load_dwordx4 v1, s[48:51], s10 offen offset:3072 nt lds
  s_add_u32 m0, m0, s12
  s_add_u32 s10, s10, s11
  s_and_b32 s10, s10, s14
  s_waitcnt vmcnt(4)
  buffer_load_dwordx4 v1, s[48:51], s10 offen offset:0 nt lds
  s_mov_b64 exec, 1
  ds_add_u32 v4, v5 offset:32
  s_mov_b64 exec, -1
  s_waitcnt vmcnt(4)
  buffer_load_dwordx4 v1, s[48:51], s10 offen offset:1024 nt lds
  s_waitcnt vmcnt(4)
  buffer_load_dwordx4 v1, s[48:51], s10 offen offset:2048 nt lds
  s_waitcnt vmcnt(4)
  buffer_load_dwordx4 v1, s[48:51], s10 offen offset:3072 nt lds
  s_add_u32 m0, m0, s12
  s_add_u32 s10, s10, s11
  s_and_b32 s10, s10, s14
  s_mov_b32 s92, 0x1222
  s_branch L_PB
L_PA1:
  buffer_load_dwordx4 v[52:55], v1, s[44:47], s10 offen offset:1024 nt
  buffer_load_dwordx4 v[56:59], v1, s[44:47], s10 offen offset:2048 nt
  buffer_load_dwordx4 v[60:63], v1, s[44:47], s10 offen offset:3072 nt
  s_add_u32 s10, s10, s11
  s_and_b32 s10, s10, s14
  buffer_load_dwordx4 v[64:67], v1, s[44:47], s10 offen offset:0 nt
  buffer_load_dwordx4 v[68:71], v1, s[44:47], s10 offen offset:1024 nt
  s_waitcnt vmcnt(4)
  buffer_load_dwordx4 v[72:75], v1, s[44:47], s10 offen offset:2048 nt
  s_waitcnt vmcnt(5)
  buffer_load_dwordx4 v[76:79], v1, s[44:47], s10 offen offset:3072 nt
  s_add_u32 s10, s10, s11
  s_and_b32 s10, s10, s14
  s_waitcnt vmcnt(4)
  buffer_load_dwordx4 v[80:83], v1, s[44:47], s10 offen offset:0 nt
  s_waitcnt vmcnt(5)
  buffer_load_dwordx4 v[84:87], v1, s[44:47], s10 offen offset:1024 nt
  s_waitcnt vmcnt(4)
  buffer_load_dwordx4 v[88:91], v1, s[44:47], s10 offen offset:2048 nt
  s_waitcnt vmcnt(5)
  buffer_load_dwordx4 v[92:95], v1, s[44:47], s10 offen offset:3072 nt
  s_add_u32 s10, s10, s11
  s_and_b32 s10, s10, s14
  s_waitcnt vmcnt(4)
  buffer_load_dwordx4 v[96:99], v1, s[44:47], s10 offen offset:0 nt
  s_waitcnt vmcnt(5)
  buffer_load_dwordx4 v[100:103], v1, s[44:47], s10 offen offset:1024 nt
  s_waitcnt vmcnt(4)
  buffer_load_dwordx4 v[104:107], v1, s[44:47], s10 offen offset:2048 nt
  s_waitcnt vmcnt(5)
  buffer_load_dwordx4 v[108:111], v1, s[44:47], s10 offen offset:3072 nt
  s_add_u32 s10, s10, s11
  s_and_b32 s10, s10, s14
  s_waitcnt vmcnt(4)
  buffer_load_dwordx4 v[112:115], v1, s[44:47], s10 offen offset:0 nt
  s_waitcnt vmcnt(5)
  buffer_load_dwordx4 v[116:119], v1, s[44:47], s10 offen offset:1024 nt
  s_waitcnt vmcnt(4)
  buffer_load_dwordx4 v[120:123], v1, s[44:47], s10 offen offset:2048 nt
  s_waitcnt vmcnt(5)
  buffer_load_dwordx4 v[124:127], v1, s[44:47], s10 offen offset:3072 nt
  s_add_u32 s10, s10, s11
  s_and_b32 s10, s10, s14
  s_waitcnt vmcnt(4)
  buffer_load_dwordx4 v[128:131], v1, s[44:47], s10 offen offset:0 nt
  s_waitcnt vmcnt(5)
  buffer_load_dwordx4 v[132:135], v1, s[44:47], s10 offen offset:1024 nt
  s_waitcnt vmcnt(4)
  buffer_load_dwordx4 v[136:139], v1, s[44:47], s10 offen offset:2048 nt
  s_waitcnt vmcnt(5)
  buffer_load_dwordx4 v[140:143], v1, s[44:47], s10 offen offset:3072 nt
  s_add_u32 s10, s10, s11
  s_and_b32 s10, s10, s14
  s_waitcnt vmcnt(4)
  buffer_load_dwordx4 v[144:147], v1, s[44:47], s10 offen offset:0 nt
  s_mov_b64 exec, 1
  ds_add_u32 v4, v5 offset:44
  s_mov_b64 exec, -1
  s_waitcnt vmcnt(5)
  buffer_load_dwordx4 v[148:151], v1, s[44:47], s10 offen offset:1024 nt
  s_waitcnt vmcnt(4)
  buffer_load_dwordx4 v[152:155], v1, s[44:47], s10 offen offset:2048 nt
  s_waitcnt vmcnt(5)
  buffer_load_dwordx4 v[156:159], v1, s[44:47], s10 offen offset:3072 nt
  s_add_u32 s10, s10, s11
  s_and_b32 s10, s10, s14
  s_waitcnt vmcnt(4)
  buffer_load_dwordx4 v[160:163], v1, s[44:47], s10 offen offset:0 nt
  s_waitcnt vmcnt(5)
  buffer_load_dwordx4 v[164:167], v1, s[44:47], s10 offen offset:1024 nt
  s_waitcnt vmcnt(4)
  buffer_load_dwordx4 v[168:171], v1, s[44:47], s10 offen offset:2048 nt
  s_waitcnt vmcnt(5)
  buffer_load_dwordx4 v[172:175], v1, s[44:47], s10 offen offset:3072 nt
  s_add_u32 s10, s10, s11
  s_and_b32 s10, s10, s14
  s_waitcnt vmcnt(4)
  buffer_load_dwordx4 v[176:179], v1, s[44:47], s10 offen offset:0 nt
  s_waitcnt vmcnt(5)
  buffer_load_dwordx4 v[180:183], v1, s[44:47], s10 offen offset:1024 nt
  s_waitcnt vmcnt(4)
  buffer_load_dwordx4 v[184:187], v1, s[44:47], s10 offen offset:2048 nt
  s_waitcnt vmcnt(5)
  buffer_load_dwordx4 v[188:191], v1, s[44:47], s10 offen offset:3072 nt
  s_add_u32 s10, s10, s11
  s_and_b32 s10, s10, s14
  s_waitcnt vmcnt(4)
  buffer_load_dwordx4 v[192:195], v1, s[44:47], s10 offen offset:0 nt
  s_waitcnt vmcnt(5)
  buffer_load_dwordx4 v[196:199], v1, s[44:47], s10 offen offset:1024 nt
  s_waitcnt vmcnt(4)
  buffer_load_dwordx4 v[200:203], v1, s[44:47], s10 offen offset:2048 nt
  s_waitcnt vmcnt(5)
  buffer_load_dwordx4 v[204:207], v1, s[44:47], s10 offen offset:3072 nt
  s_add_u32 s10, s10, s11
  s_and_b32 s10, s10, s14
  s_waitcnt vmcnt(4)
  buffer_load_dwordx4 v[208:211], v1, s[44:47], s10 offen offset:0 nt
  s_waitcnt vmcnt(5)
  buffer_load_dwordx4 v[212:215], v1, s[44:47], s10 offen offset:1024 nt
  s_waitcnt vmcnt(4)
  buffer_load_dwordx4 v[216:219], v1, s[44:47], s10 offen offset:2048 nt
  s_waitcnt vmcnt(5)
  buffer_load_dwordx4 v[220:223], v1, s[44:47], s10 offen offset:3072 nt
  s_add_u32 s10, s10, s11
  s_and_b32 s10, s10, s14
  s_waitcnt vmcnt(4)
  buffer_load_dwordx4 v[224:227], v1, s[44:47], s10 offen offset:0 nt
  s_mov_b64 exec, 1
  ds_add_u32 v4, v5 offset:28
  s_mov_b64 exec, -1
  s_waitcnt vmcnt(5)
  buffer_load_dwordx4 v[228:231], v1, s[44:47], s10 offen offset:1024 nt
  s_waitcnt vmcnt(4)
  buffer_load_dwordx4 v[232:235], v1, s[44:47], s10 offen offset:2048 nt
  s_waitcnt vmcnt(5)
  buffer_load_dwordx4 v[236:239], v1, s[44:47], s10 offen offset:3072 nt
  s_add_u32 s10, s10, s11
  s_and_b32 s10, s10, s14
  s_mov_b32 s7, 1048576
LW_11:
  ds_read_b32 v6, v4 offset:16
  s_waitcnt lgkmcnt(0)
  v_cmp_le_u32 vcc, 4, v6
  s_cbranch_vccnz LWd_12
  s_sub_u32 s7, s7, 1
  s_cbranch_scc0 LW_11
  s_branch L_END
LWd_12:
  s_waitcnt vmcnt(4)
  buffer_load_dwordx4 v1, s[44:47], s10 offen offset:0 nt lds
  s_waitcnt vmcnt(5)
  buffer_load_dwordx4 v1, s[44:47], s10 offen offset:1024 nt lds
  s_waitcnt vmcnt(4)
  buffer_load_dwordx4 v1, s[44:47], s10 offen offset:2048 nt lds
  s_waitcnt vmcnt(5)
  buffer_load_dwordx4 v1, s[44:47], s10 offen offset:3072 nt lds
  s_add_u32 m0, m0, s12
  s_add_u32 s10, s10, s11
  s_and_b32 s10, s10, s14
  s_waitcnt vmcnt(4)
  buffer_load_dwordx4 v1, s[44:47], s10 offen offset:0 nt lds
  s_mov_b64 exec, 1
  ds_add_u32 v4, v5 offset:64
  s_mov_b64 exec, -1
  s_waitcnt vmcnt(5)
  buffer_load_dwordx4 v1, s[44:47], s10 offen offset:1024 nt lds
  s_waitcnt vmcnt(4)
  buffer_load_dwordx4 v1, s[44:47], s10 offen offset:2048 nt lds
  s_waitcnt vmcnt(5)
  buffer_load_dwordx4 v1, s[44:47], s10 offen offset:3072 nt lds
  s_add_u32 m0, m0, s12
  s_add_u32 s10, s10, s11
  s_and_b32 s10, s10, s14
  s_waitcnt vmcnt(4)
  buffer_load_dwordx4 v1, s[44:47], s10 offen offset:0 nt lds
  s_waitcnt vmcnt(5)
  buffer_load_dwordx4 v1, s[44:47], s10 offen offset:1024 nt lds
  s_waitcnt vmcnt(4)
  buffer_load_dwordx4 v1, s[44:47], s10 offen offset:2048 nt lds
  s_waitcnt vmcnt(5)
  buffer_load_dwordx4 v1, s[44:47], s10 offen offset:3072 nt lds
  s_add_u32 m0, m0, s12
  s_add_u32 s10, s10, s11
  s_and_b32 s10, s10, s14
  s_waitcnt vmcnt(4)
  buffer_load_dwordx4 v1, s[44:47], s10 offen offset:0 nt lds
  s_waitcnt vmcnt(5)
  buffer_load_dwordx4 v1, s[44:47], s10 offen offset:1024 nt lds
  s_waitcnt vmcnt(4)
  buffer_load_dwordx4 v1, s[44:47], s10 offen offset:2048 nt lds
  s_waitcnt vmcnt(5)
  buffer_load_dwordx4 v1, s[44:47], s10 offen offset:3072 nt lds
  s_add_u32 m0, m0, s12
  s_add_u32 s10, s10, s11
  s_and_b32 s10, s10, s14
  s_waitcnt vmcnt(4)
  buffer_load_dwordx4 v1, s[48:51], s10 offen offset:0 nt lds
  s_waitcnt vmcnt(5)
  buffer_load_dwordx4 v1, s[48:51], s10 offen offset:1024 nt lds
  s_waitcnt vmcnt(4)
  buffer_load_dwordx4 v1, s[48:51], s10 offen offset:2048 nt lds
  s_waitcnt vmcnt(5)
  buffer_load_dwordx4 v1, s[48:51], s10 offen offset:3072 nt lds
  s_add_u32 m0, m0, s12
  s_add_u32 s10, s10, s11
  s_and_b32 s10, s10, s14
  s_waitcnt vmcnt(4)
  buffer_load_dwordx4 v1, s[48:51], s10 offen offset:0 nt lds
  s_waitcnt vmcnt(5)
  buffer_load_dwordx4 v1, s[48:51], s10 offen offset:1024 nt lds
  s_waitcnt vmcnt(4)
  buffer_load_dwordx4 v1, s[48:51], s10 offen offset:2048 nt lds
  s_waitcnt vmcnt(5)
  buffer_load_dwordx4 v1, s[48:51], s10 offen offset:3072 nt lds
  s_add_u32 m0, m0, s12
  s_add_u32 s10, s10, s11
  s_and_b32 s10, s10, s14
  s_waitcnt vmcnt(4)
  buffer_load_dwordx4 v1, s[48:51], s10 offen offset:0 nt lds
  s_mov_b64 exec, 1
  ds_add_u32 v4, v5 offset:32
  s_mov_b64 exec, -1
  s_waitcnt vmcnt(5)
  buffer_load_dwordx4 v1, s[48:51], s10 offen offset:1024 nt lds
  s_waitcnt vmcnt(4)
  buffer_load_dwordx4 v1, s[48:51], s10 offen offset:2048 nt lds
  s_waitcnt vmcnt(5)
  buffer_load_dwordx4 v1, s[48:51], s10 offen offset:3072 nt lds
  s_add_u32 m0, m0, s12
  s_add_u32 s10, s10, s11
  s_and_b32 s10, s10, s14
  s_mov_b32 s92, 0x1122
  s_branch L_PB
L_PA2:
  buffer_load_dwordx4 v[52:55], v1, s[44:47], s10 offen offset:1024 nt
  buffer_load_dwordx4 v[56:59], v1, s[44:47], s10 offen offset:2048 nt
  buffer_load_dwordx4 v[60:63], v1, s[44:47], s10 offen offset:3072 nt
  s_add_u32 s10, s10, s11
  s_and_b32 s10, s10, s14
  buffer_load_dwordx4 v[64:67], v1, s[44:47], s10 offen offset:0 nt
  buffer_load_dwordx4 v[68:71], v1, s[44:47], s10 offen offset:1024 nt
  buffer_load_dwordx4 v[72:75], v1, s[44:47], s10 offen offset:2048 nt
  buffer_load_dwordx4 v[76:79], v1, s[44:47], s10 offen offset:3072 nt
  s_add_u32 s10, s10, s11
  s_and_b32 s10, s10, s14
  s_waitcnt vmcnt(6)
  buffer_load_dwordx4 v[80:83], v1, s[44:47], s10 offen offset:0 nt
  s_waitcnt vmcnt(7)
  buffer_load_dwordx4 v[84:87], v1, s[44:47], s10 offen offset:1024 nt
  s_waitcnt vmcnt(6)
  buffer_load_dwordx4 v[88:91], v1, s[44:47], s10 offen offset:2048 nt
  s_waitcnt vmcnt(7)
  buffer_load_dwordx4 v[92:95], v1, s[44:47], s10 offen offset:3072 nt
  s_add_u32 s10, s10, s11
  s_and_b32 s10, s10, s14
  s_waitcnt vmcnt(6)
  buffer_load_dwordx4 v[96:99], v1, s[44:47], s10 offen offset:0 nt
  s_waitcnt vmcnt(7)
  buffer_load_dwordx4 v[100:103], v1, s[44:47], s10 offen offset:1024 nt
  s_waitcnt vmcnt(6)
  buffer_load_dwordx4 v[104:107], v1, s[44:47], s10 offen offset:2048 nt
  s_waitcnt vmcnt(7)
  buffer_load_dwordx4 v[108:111], v1, s[44:47], s10 offen offset:3072 nt
  s_add_u32 s10, s10, s11
  s_and_b32 s10, s10, s14
  s_waitcnt vmcnt(6)
  buffer_load_dwordx4 v[112:115], v1, s[44:47], s10 offen offset:0 nt
  s_waitcnt vmcnt(7)
  buffer_load_dwordx4 v[116:119], v1, s[44:47], s10 offen offset:1024 nt
  s_waitcnt vmcnt(6)
  buffer_load_dwordx4 v[120:123], v1, s[44:47], s10 offen offset:2048 nt
  s_waitcnt vmcnt(7)
  buffer_load_dwordx4 v[124:127], v1, s[44:47], s10 offen offset:3072 nt
  s_add_u32 s10, s10, s11
  s_and_b32 s10, s10, s14
  s_waitcnt vmcnt(6)
  buffer_load_dwordx4 v[128:131], v1, s[44:47], s10 offen offset:0 nt
  s_waitcnt vmcnt(7)
  buffer_load_dwordx4 v[132:135], v1, s[44:47], s10 offen offset:1024 nt
  s_waitcnt vmcnt(6)
  buffer_load_dwordx4 v[136:139], v1, s[44:47], s10 offen offset:2048 nt
  s_waitcnt vmcnt(7)
  buffer_load_dwordx4 v[140:143], v1, s[44:47], s10 offen offset:3072 nt
  s_add_u32 s10, s10, s11
  s_and_b32 s10, s10, s14
  s_waitcnt vmcnt(6)
  buffer_load_dwordx4 v[144:147], v1, s[44:47], s10 offen offset:0 nt
  s_mov_b64 exec, 1
  ds_add_u32 v4, v5 offset:44
  s_mov_b64 exec, -1
  s_waitcnt vmcnt(7)
  buffer_load_dwordx4 v[148:151], v1, s[44:47], s10 offen offset:1024 nt
  s_waitcnt vmcnt(6)
  buffer_load_dwordx4 v[152:155], v1, s[44:47], s10 offen offset:2048 nt
  s_waitcnt vmcnt(7)
  buffer_load_dwordx4 v[156:159], v1, s[44:47], s10 offen offset:3072 nt
  s_add_u32 s10, s10, s11
  s_and_b32 s10, s10, s14
  s_waitcnt vmcnt(6)
  buffer_load_dwordx4 v[160:163], v1, s[44:47], s10 offen offset:0 nt
  s_waitcnt vmcnt(7)
  buffer_load_dwordx4 v[164:167], v1, s[44:47], s10 offen offset:1024 nt
  s_waitcnt vmcnt(6)
  buffer_load_dwordx4 v[168:171], v1, s[44:47], s10 offen offset:2048 nt
  s_waitcnt vmcnt(7)
  buffer_load_dwordx4 v[172:175], v1, s[44:47], s10 offen offset:3072 nt
  s_add_u32 s10, s10, s11
  s_and_b32 s10, s10, s14
  s_waitcnt vmcnt(6)
  buffer_load_dwordx4 v[176:179], v1, s[44:47], s10 offen offset:0 nt
  s_waitcnt vmcnt(7)
  buffer_load_dwordx4 v[180:183], v1, s[44:47], s10 offen offset:1024 nt
  s_waitcnt vmcnt(6)
  buffer_load_dwordx4 v[184:187], v1, s[44:47], s10 offen offset:2048 nt
  s_waitcnt vmcnt(7)
  buffer_load_dwordx4 v[188:191], v1, s[44:47], s10 offen offset:3072 nt
  s_add_u32 s10, s10, s11
  s_and_b32 s10, s10, s14
  s_waitcnt vmcnt(6)
  buffer_load_dwordx4 v[192:195], v1, s[44:47], s10 offen offset:0 nt
  s_waitcnt vmcnt(7)
  buffer_load_dwordx4 v[196:199], v1, s[44:47], s10 offen offset:1024 nt
  s_waitcnt vmcnt(6)
  buffer_load_dwordx4 v[200:203], v1, s[44:47], s10 offen offset:2048 nt
  s_waitcnt vmcnt(7)
  buffer_load_dwordx4 v[204:207], v1, s[44:47], s10 offen offset:3072 nt
  s_add_u32 s10, s10, s11
  s_and_b32 s10, s10, s14
  s_waitcnt vmcnt(6)
  buffer_load_dwordx4 v[208:211], v1, s[44:47], s10 offen offset:0 nt
  s_waitcnt vmcnt(7)
  buffer_load_dwordx4 v[212:215], v1, s[44:47], s10 offen offset:1024 nt
  s_waitcnt vmcnt(6)
  buffer_load_dwordx4 v[216:219], v1, s[44:47], s10 offen offset:2048 nt
  s_waitcnt vmcnt(7)
  buffer_load_dwordx4 v[220:223], v1, s[44:47], s10 offen offset:3072 nt
  s_add_u32 s10, s10, s11
  s_and_b32 s10, s10, s14
  s_waitcnt vmcnt(6)
  buffer_load_dwordx4 v[224:227], v1, s[44:47], s10 offen offset:0 nt
  s_mov_b64 exec, 1
  ds_add_u32 v4, v5 offset:28
  s_mov_b64 exec, -1
  s_waitcnt vmcnt(7)
  buffer_load_dwordx4 v[228:231], v1, s[44:47], s10 offen offset:1024 nt
  s_waitcnt vmcnt(6)
  buffer_load_dwordx4 v[232:235], v1, s[44:47], s10 offen offset:2048 nt
  s_waitcnt vmcnt(7)
  buffer_load_dwordx4 v[236:239], v1, s[44:47], s10 offen offset:3072 nt
  s_add_u32 s10, s10, s11
  s_and_b32 s10, s10, s14
  s_mov_b32 s7, 1048576
LW_13:
  ds_read_b32 v6, v4 offset:16
  s_waitcnt lgkmcnt(0)
  v_cmp_le_u32 vcc, 4, v6
  s_cbranch_vccnz LWd_14
  s_sub_u32 s7, s7, 1
  s_cbranch_scc0 LW_13
  s_branch L_END
LWd_14:
  s_waitcnt vmcnt(6)
  buffer_load_dwordx4 v1, s[44:47], s10 offen offset:0 nt lds
  s_waitcnt vmcnt(7)
  buffer_load_dwordx4 v1, s[44:47], s10 offen offset:1024 nt lds
  s_waitcnt vmcnt(6)
  buffer_load_dwordx4 v1, s[44:47], s10 offen offset:2048 nt lds
  s_waitcnt vmcnt(7)
  buffer_load_dwordx4 v1, s[44:47], s10 offen offset:3072 nt lds
  s_add_u32 m0, m0, s12
  s_add_u32 s10, s10, s11
  s_and_b32 s10, s10, s14
  s_waitcnt vmcnt(6)
  buffer_load_dwordx4 v1, s[44:47], s10 offen offset:0 nt lds
  s_mov_b64 exec, 1
  ds_add_u32 v4, v5 offset:64
  s_mov_b64 exec, -1
  s_waitcnt vmcnt(7)
  buffer_load_dwordx4 v1, s[44:47], s10 offen offset:1024 nt lds
  s_waitcnt vmcnt(6)
  buffer_load_dwordx4 v1, s[44:47], s10 offen offset:2048 nt lds
  s_waitcnt vmcnt(7)
  buffer_load_dwordx4 v1, s[44:47], s10 offen offset:3072 nt lds
  s_add_u32 m0, m0, s12
  s_add_u32 s10, s10, s11
  s_and_b32 s10, s10, s14
  s_waitcnt vmcnt(6)
  buffer_load_dwordx4 v1, s[44:47], s10 offen offset:0 nt lds
  s_waitcnt vmcnt(7)
  buffer_load_dwordx4 v1, s[44:47], s10 offen offset:1024 nt lds
  s_waitcnt vmcnt(6)
  buffer_load_dwordx4 v1, s[44:47], s10 offen offset:2048 nt lds
  s_waitcnt vmcnt(7)
  buffer_load_dwordx4 v1, s[44:47], s10 offen offset:3072 nt lds
  s_add_u32 m0, m0, s12
  s_add_u32 s10, s10, s11
  s_and_b32 s10, s10, s14
  s_waitcnt vmcnt(7)
  buffer_load_dwordx4 v1, s[44:47], s10 offen offset:0 nt lds
  s_waitcnt vmcnt(7)
  buffer_load_dwordx4 v1, s[44:47], s10 offen offset:1024 nt lds
  s_waitcnt vmcnt(7)
  buffer_load_dwordx4 v1, s[44:47], s10 offen offset:2048 nt lds
  s_waitcnt vmcnt(7)
  buffer_load_dwordx4 v1, s[44:47], s10 offen offset:3072 nt lds
  s_add_u32 m0, m0, s12
  s_add_u32 s10, s10, s11
  s_and_b32 s10, s10, s14
  s_waitcnt vmcnt(7)
  buffer_load_dwordx4 v1, s[48:51], s10 offen offset:0 nt lds
  s_waitcnt vmcnt(7)
  buffer_load_dwordx4 v1, s[48:51], s10 offen offset:1024 nt lds
  s_waitcnt vmcnt(7)
  buffer_load_dwordx4 v1, s[48:51], s10 offen offset:2048 nt lds
  s_waitcnt vmcnt(7)
  buffer_load_dwordx4 v1, s[48:51], s10 offen offset:3072 nt lds
  s_add_u32 m0, m0, s12
  s_add_u32 s10, s10, s11
  s_and_b32 s10, s10, s14
  s_waitcnt vmcnt(7)
  buffer_load_dwordx4 v1, s[48:51], s10 offen offset:0 nt lds
  s_waitcnt vmcnt(7)
  buffer_load_dwordx4 v1, s[48:51], s10 offen offset:1024 nt lds
  s_waitcnt vmcnt(7)
  buffer_load_dwordx4 v1, s[48:51], s10 offen offset:2048 nt lds
  s_waitcnt vmcnt(7)
  buffer_load_dwordx4 v1, s[48:51], s10 offen offset:3072 nt lds
  s_add_u32 m0, m0, s12
  s_add_u32 s10, s10, s11
  s_and_b32 s10, s10, s14
  s_waitcnt vmcnt(7)
  buffer_load_dwordx4 v1, s[48:51], s10 offen offset:0 nt lds
  s_mov_b64 exec, 1
  ds_add_u32 v4, v5 offset:32
  s_mov_b64 exec, -1
  s_waitcnt vmcnt(7)
  buffer_load_dwordx4 v1, s[48:51], s10 offen offset:1024 nt lds
  s_waitcnt vmcnt(7)
  buffer_load_dwordx4 v1, s[48:51], s10 offen offset:2048 nt lds
  s_waitcnt vmcnt(7)
  buffer_load_dwordx4 v1, s[48:51], s10 offen offset:3072 nt lds
  s_add_u32 m0, m0, s12
  s_add_u32 s10, s10, s11
  s_and_b32 s10, s10, s14
  s_mov_b32 s92, 0x0
L_PB:
  s_cmp_ge_u32 s98, 283
  s_cselect_b32 s94, 1, s94
  s_cselect_b32 s92, 0x0011, s92
  s_mov_b32 s7, 1048576
LW_15:
  ds_read_b32 v6, v4 offset:4
  s_waitcnt lgkmcnt(0)
  v_cmp_le_u32 vcc, 1, v6
  s_cbranch_vccnz LWd_16
  s_sub_u32 s7, s7, 1
  s_cbranch_scc0 LW_15
  s_branch L_END
LWd_16:
  ds_read_b128 v[12:15], v2 offset:256
  s_waitcnt lgkmcnt(0)
  s_cmp_eq_u32 s94, 0
  s_cbranch_scc1 TH_17
  s_waitcnt vmcnt(6)
  s_cmp_lt_u32 s94, 2
  s_cbranch_scc1 TH_17
  s_waitcnt vmcnt(5)
TH_17:
  s_waitcnt vmcnt(7)
  buffer_load_dwordx4 v[240:243], v1, s[48:51], s10 offen offset:0 nt
  v_dot2_f32_bf16 v24, v48, v12, 0
  v_dot2_f32_bf16 v25, v52, v12, 0
  v_dot2_f32_bf16 v26, v56, v12, 0
  v_dot2_f32_bf16 v27, v60, v12, 0
  v_dot2_f32_bf16 v24, v49, v13, v24
  v_dot2_f32_bf16 v25, v53, v13, v25
  v_dot2_f32_bf16 v26, v57, v13, v26
  v_dot2_f32_bf16 v27, v61, v13, v27
  v_dot2_f32_bf16 v24, v50, v14, v24
  v_dot2_f32_bf16 v25, v54, v14, v25
  v_dot2_f32_bf16 v26, v58, v14, v26
  v_dot2_f32_bf16 v27, v62, v14, v27
  v_dot2_f32_bf16 v24, v51, v15, v24
  v_dot2_f32_bf16 v25, v55, v15, v25
  v_dot2_f32_bf16 v26, v59, v15, v26
  v_dot2_f32_bf16 v27, v63, v15, v27
  v_add_f32_dpp v28, v24, v24 row_ror:8 row_mask:0xf bank_mask:0x3
  v_add_f32_dpp v28, v25, v25 row_ror:8 row_mask:0xf bank_mask:0xc
  v_add_f32_dpp v29, v26, v26 row_ror:8 row_mask:0xf bank_mask:0x3
  v_add_f32_dpp v29, v27, v27 row_ror:8 row_mask:0xf bank_mask:0xc
  v_add_f32_dpp v30, v28, v28 row_half_mirror row_mask:0xf bank_mask:0x5
  s_nop 0
  v_add_f32_dpp v30, v29, v29 row_half_mirror row_mask:0xf bank_mask:0xa
  s_nop 1
  v_add_f32_dpp v30, v30, v30 quad_perm:[1,0,3,2] row_mask:0xf bank_mask:0xf
  s_nop 1
  v_add_f32_dpp v32, v30, v30 quad_perm:[2,3,0,1] row_mask:0xf bank_mask:0xf
  ds_read_b128 v[244:247], v7 offset:0
  ds_read_b128 v[248:251], v7 offset:1024
  ds_read_b128 v[48:51], v7 offset:2048
  v_dot2_f32_bf16 v24, v64, v12, 0
  v_dot2_f32_bf16 v25, v68, v12, 0
  v_dot2_f32_bf16 v26, v72, v12, 0
  v_dot2_f32_bf16 v27, v76, v12, 0
  v_dot2_f32_bf16 v24, v65, v13, v24
  v_dot2_f32_bf16 v25, v69, v13, v25
  v_dot2_f32_bf16 v26, v73, v13, v26
  v_dot2_f32_bf16 v27, v77, v13, v27
  v_dot2_f32_bf16 v24, v66, v14, v24
  v_dot2_f32_bf16 v25, v70, v14, v25
  v_dot2_f32_bf16 v26, v74, v14, v26
  v_dot2_f32_bf16 v27, v78, v14, v27
  v_dot2_f32_bf16 v24, v67, v15, v24
  v_dot2_f32_bf16 v25, v71, v15, v25
  v_dot2_f32_bf16 v26, v75, v15, v26
  v_dot2_f32_bf16 v27, v79, v15, v27
  v_add_f32_dpp v28, v24, v24 row_ror:8 row_mask:0xf bank_mask:0x3
  v_add_f32_dpp v28, v25, v25 row_ror:8 row_mask:0xf bank_mask:0xc
  v_add_f32_dpp v29, v26, v26 row_ror:8 row_mask:0xf bank_mask:0x3
  v_add_f32_dpp v29, v27, v27 row_ror:8 row_mask:0xf bank_mask:0xc
  v_add_f32_dpp v30, v28, v28 row_half_mirror row_mask:0xf bank_mask:0x5
  s_nop 0
  v_add_f32_dpp v30, v29, v29 row_half_mirror row_mask:0xf bank_mask:0xa
  s_nop 1
  v_add_f32_dpp v30, v30, v30 quad_perm:[1,0,3,2] row_mask:0xf bank_mask:0xf
  s_nop 1
  v_add_f32_dpp v33, v30, v30 quad_perm:[2,3,0,1] row_mask:0xf bank_mask:0xf
  ds_read_b128 v[52:55], v7 offset:3072
  ds_read_b128 v[56:59], v7 offset:4096
  ds_read_b128 v[60:63], v7 offset:5120
  ds_read_b128 v[64:67], v7 offset:6144
  s_cmp_eq_u32 s94, 0
  s_cbranch_scc1 TH_18
  s_waitcnt vmcnt(6)
  s_cmp_lt_u32 s94, 2
  s_cbranch_scc1 TH_18
  s_waitcnt vmcnt(5)
TH_18:
  s_waitcnt vmcnt(7)
  buffer_load_dwordx4 v[68:71], v1, s[48:51], s10 offen offset:1024 nt
  v_dot2_f32_bf16 v24, v80, v12, 0
  v_dot2_f32_bf16 v25, v84, v12, 0
  v_dot2_f32_bf16 v26, v88, v12, 0
  v_dot2_f32_bf16 v27, v92, v12, 0
  v_dot2_f32_bf16 v24, v81, v13, v24
  v_dot2_f32_bf16 v25, v85, v13, v25
  v_dot2_f32_bf16 v26, v89, v13, v26
  v_dot2_f32_bf16 v27, v93, v13, v27
  v_dot2_f32_bf16 v24, v82, v14, v24
  v_dot2_f32_bf16 v25, v86, v14, v25
  v_dot2_f32_bf16 v26, v90, v14, v26
  v_dot2_f32_bf16 v27, v94, v14, v27
  v_dot2_f32_bf16 v24, v83, v15, v24
  v_dot2_f32_bf16 v25, v87, v15, v25
  v_dot2_f32_bf16 v26, v91, v15, v26
  v_dot2_f32_bf16 v27, v95, v15, v27
  v_add_f32_dpp v28, v24, v24 row_ror:8 row_mask:0xf bank_mask:0x3
  v_add_f32_dpp v28, v25, v25 row_ror:8 row_mask:0xf bank_mask:0xc
  v_add_f32_dpp v29, v26, v26 row_ror:8 row_mask:0xf bank_mask:0x3
  v_add_f32_dpp v29, v27, v27 row_ror:8 row_mask:0xf bank_mask:0xc
  v_add_f32_dpp v30, v28, v28 row_half_mirror row_mask:0xf bank_mask:0x5
  s_nop 0
  v_add_f32_dpp v30, v29, v29 row_half_mirror row_mask:0xf bank_mask:0xa
  s_nop 1
  v_add_f32_dpp v30, v30, v30 quad_perm:[1,0,3,2] row_mask:0xf bank_mask:0xf
  s_nop 1
  v_add_f32_dpp v34, v30, v30 quad_perm:[2,3,0,1] row_mask:0xf bank_mask:0xf
  ds_read_b128 v[72:75], v7 offset:7168
  ds_read_b128 v[76:79], v7 offset:8192
  ds_read_b128 v[80:83], v7 offset:9216
  v_dot2_f32_bf16 v24, v96, v12, 0
  v_dot2_f32_bf16 v25, v100, v12, 0
  v_dot2_f32_bf16 v26, v104, v12, 0
  v_dot2_f32_bf16 v27, v108, v12, 0
  v_dot2_f32_bf16 v24, v97, v13, v24
  v_dot2_f32_bf16 v25, v101, v13, v25
  v_dot2_f32_bf16 v26, v105, v13, v26
  v_dot2_f32_bf16 v27, v109, v13, v27
  v_dot2_f32_bf16 v24, v98, v14, v24
  v_dot2_f32_bf16 v25, v102, v14, v25
  v_dot2_f32_bf16 v26, v106, v14, v26
  v_dot2_f32_bf16 v27, v110, v14, v27
  v_dot2_f32_bf16 v24, v99, v15, v24
  v_dot2_f32_bf16 v25, v103, v15, v25
  v_dot2_f32_bf16 v26, v107, v15, v26
  v_dot2_f32_bf16 v27, v111, v15, v27
  v_add_f32_dpp v28, v24, v24 row_ror:8 row_mask:0xf bank_mask:0x3
  v_add_f32_dpp v28, v25, v25 row_ror:8 row_mask:0xf bank_mask:0xc
  v_add_f32_dpp v29, v26, v26 row_ror:8 row_mask:0xf bank_mask:0x3
  v_add_f32_dpp v29, v27, v27 row_ror:8 row_mask:0xf bank_mask:0xc
  v_add_f32_dpp v30, v28, v28 row_half_mirror row_mask:0xf bank_mask:0x5
  s_nop 0
  v_add_f32_dpp v30, v29, v29 row_half_mirror row_mask:0xf bank_mask:0xa
  s_nop 1
  v_add_f32_dpp v30, v30, v30 quad_perm:[1,0,3,2] row_mask:0xf bank_mask:0xf
  s_nop 1
  v_add_f32_dpp v35, v30, v30 quad_perm:[2,3,0,1] row_mask:0xf bank_mask:0xf
  ds_read_b128 v[84:87], v7 offset:10240
  ds_read_b128 v[88:91], v7 offset:11264
  s_cmp_eq_u32 s94, 0
  s_cbranch_scc1 TH_19
  s_waitcnt vmcnt(6)
  s_cmp_lt_u32 s94, 2
  s_cbranch_scc1 TH_19
  s_waitcnt vmcnt(5)
TH_19:
  s_waitcnt vmcnt(7)
  buffer_load_dwordx4 v[92:95], v1, s[48:51], s10 offen offset:2048 nt
  s_mov_b64 exec, 1
  ds_add_rtn_u32 v6, v4, v5 offset:80
  s_mov_b64 exec, -1
  s_waitcnt lgkmcnt(0)
  v_readfirstlane_b32 s8, v6
  s_nop 0
  s_sub_i32 s8, s8, 0
  s_max_i32 s8, s8, 0
  s_min_i32 s8, s8, 3
  s_lshl_b32 s8, s8, 2
  s_lshr_b32 s8, s92, s8
  s_and_b32 s94, s8, 3
  v_dot2_f32_bf16 v24, v112, v12, 0
  v_dot2_f32_bf16 v25, v116, v12, 0
  v_dot2_f32_bf16 v26, v120, v12, 0
  v_dot2_f32_bf16 v27, v124, v12, 0
  v_dot2_f32_bf16 v24, v113, v13, v24
  v_dot2_f32_bf16 v25, v117, v13, v25
  v_dot2_f32_bf16 v26, v121, v13, v26
  v_dot2_f32_bf16 v27, v125, v13, v27
  v_dot2_f32_bf16 v24, v114, v14, v24
  v_dot2_f32_bf16 v25, v118, v14, v25
  v_dot2_f32_bf16 v26, v122, v14, v26
  v_dot2_f32_bf16 v27, v126, v14, v27
  v_dot2_f32_bf16 v24, v115, v15, v24
  v_dot2_f32_bf16 v25, v119, v15, v25
  v_dot2_f32_bf16 v26, v123, v15, v26
  v_dot2_f32_bf16 v27, v127, v15, v27
  v_add_f32_dpp v28, v24, v24 row_ror:8 row_mask:0xf bank_mask:0x3
  v_add_f32_dpp v28, v25, v25 row_ror:8 row_mask:0xf bank_mask:0xc
  v_add_f32_dpp v29, v26, v26 row_ror:8 row_mask:0xf bank_mask:0x3
  v_add_f32_dpp v29, v27, v27 row_ror:8 row_mask:0xf bank_mask:0xc
  v_add_f32_dpp v30, v28, v28 row_half_mirror row_mask:0xf bank_mask:0x5
  s_nop 0
  v_add_f32_dpp v30, v29, v29 row_half_mirror row_mask:0xf bank_mask:0xa
  s_nop 1
  v_add_f32_dpp v30, v30, v30 quad_perm:[1,0,3,2] row_mask:0xf bank_mask:0xf
  s_nop 1
  v_add_f32_dpp v36, v30, v30 quad_perm:[2,3,0,1] row_mask:0xf bank_mask:0xf
  ds_read_b128 v[96:99], v7 offset:12288
  ds_read_b128 v[100:103], v7 offset:13312
  ds_read_b128 v[104:107], v7 offset:14336
  v_dot2_f32_bf16 v24, v128, v12, 0
  v_dot2_f32_bf16 v25, v132, v12, 0
  v_dot2_f32_bf16 v26, v136, v12, 0
  v_dot2_f32_bf16 v27, v140, v12, 0
  v_dot2_f32_bf16 v24, v129, v13, v24
  v_dot2_f32_bf16 v25, v133, v13, v25
  v_dot2_f32_bf16 v26, v137, v13, v26
  v_dot2_f32_bf16 v27, v141, v13, v27
  v_dot2_f32_bf16 v24, v130, v14, v24
  v_dot2_f32_bf16 v25, v134, v14, v25
  v_dot2_f32_bf16 v26, v138, v14, v26
  v_dot2_f32_bf16 v27, v142, v14, v27
  v_dot2_f32_bf16 v24, v131, v15, v24
  v_dot2_f32_bf16 v25, v135, v15, v25
  v_dot2_f32_bf16 v26, v139, v15, v26
  v_dot2_f32_bf16 v27, v143, v15, v27
  v_add_f32_dpp v28, v24, v24 row_ror:8 row_mask:0xf bank_mask:0x3
  v_add_f32_dpp v28, v25, v25 row_ror:8 row_mask:0xf bank_mask:0xc
  v_add_f32_dpp v29, v26, v26 row_ror:8 row_mask:0xf bank_mask:0x3
  v_add_f32_dpp v29, v27, v27 row_ror:8 row_mask:0xf bank_mask:0xc
  v_add_f32_dpp v30, v28, v28 row_half_mirror row_mask:0xf bank_mask:0x5
  s_nop 0
  v_add_f32_dpp v30, v29, v29 row_half_mirror row_mask:0xf bank_mask:0xa
  s_nop 1
  v_add_f32_dpp v30, v30, v30 quad_perm:[1,0,3,2] row_mask:0xf bank_mask:0xf
  s_nop 1
  v_add_f32_dpp v37, v30, v30 quad_perm:[2,3,0,1] row_mask:0xf bank_mask:0xf
  s_cmp_eq_u32 s94, 0
  s_cbranch_scc1 TH_20
  s_waitcnt vmcnt(6)
  s_cmp_lt_u32 s94, 2
  s_cbranch_scc1 TH_20
  s_waitcnt vmcnt(5)
TH_20:
  s_waitcnt vmcnt(7)
  buffer_load_dwordx4 v[108:111], v1, s[48:51], s10 offen offset:3072 nt
  s_add_u32 s10, s10, s11
  s_and_b32 s10, s10, s14
  v_dot2_f32_bf16 v24, v144, v12, 0
  v_dot2_f32_bf16 v25, v148, v12, 0
  v_dot2_f32_bf16 v26, v152, v12, 0
  v_dot2_f32_bf16 v27, v156, v12, 0
  v_dot2_f32_bf16 v24, v145, v13, v24
  v_dot2_f32_bf16 v25, v149, v13, v25
  v_dot2_f32_bf16 v26, v153, v13, v26
  v_dot2_f32_bf16 v27, v157, v13, v27
  v_dot2_f32_bf16 v24, v146, v14, v24
  v_dot2_f32_bf16 v25, v150, v14, v25
  v_dot2_f32_bf16 v26, v154, v14, v26
  v_dot2_f32_bf16 v27, v158, v14, v27
  v_dot2_f32_bf16 v24, v147, v15, v24
  v_dot2_f32_bf16 v25, v151, v15, v25
  v_dot2_f32_bf16 v26, v155, v15, v26
  v_dot2_f32_bf16 v27, v159, v15, v27
  v_add_f32_dpp v28, v24, v24 row_ror:8 row_mask:0xf bank_mask:0x3
  v_add_f32_dpp v28, v25, v25 row_ror:8 row_mask:0xf bank_mask:0xc
  v_add_f32_dpp v29, v26, v26 row_ror:8 row_mask:0xf bank_mask:0x3
  v_add_f32_dpp v29, v27, v27 row_ror:8 row_mask:0xf bank_mask:0xc
  v_add_f32_dpp v30, v28, v28 row_half_mirror row_mask:0xf bank_mask:0x5
  s_nop 0
  v_add_f32_dpp v30, v29, v29 row_half_mirror row_mask:0xf bank_mask:0xa
  s_nop 1
  v_add_f32_dpp v30, v30, v30 quad_perm:[1,0,3,2] row_mask:0xf bank_mask:0xf
  s_nop 1
  v_add_f32_dpp v38, v30, v30 quad_perm:[2,3,0,1] row_mask:0xf bank_mask:0xf
  ds_read_b128 v[112:115], v7 offset:15360
  v_dot2_f32_bf16 v24, v160, v12, 0
  v_dot2_f32_bf16 v25, v164, v12, 0
  v_dot2_f32_bf16 v26, v168, v12, 0
  v_dot2_f32_bf16 v27, v172, v12, 0
  v_dot2_f32_bf16 v24, v161, v13, v24
  v_dot2_f32_bf16 v25, v165, v13, v25
  v_dot2_f32_bf16 v26, v169, v13, v26
  v_dot2_f32_bf16 v27, v173, v13, v27
  v_dot2_f32_bf16 v24, v162, v14, v24
  v_dot2_f32_bf16 v25, v166, v14, v25
  v_dot2_f32_bf16 v26, v170, v14, v26
  v_dot2_f32_bf16 v27, v174, v14, v27
  v_dot2_f32_bf16 v24, v163, v15, v24
  v_dot2_f32_bf16 v25, v167, v15, v25
  v_dot2_f32_bf16 v26, v171, v15, v26
  v_dot2_f32_bf16 v27, v175, v15, v27
  v_add_f32_dpp v28, v24, v24 row_ror:8 row_mask:0xf bank_mask:0x3
  v_add_f32_dpp v28, v25, v25 row_ror:8 row_mask:0xf bank_mask:0xc
  v_add_f32_dpp v29, v26, v26 row_ror:8 row_mask:0xf bank_mask:0x3
  v_add_f32_dpp v29, v27, v27 row_ror:8 row_mask:0xf bank_mask:0xc
  v_add_f32_dpp v30, v28, v28 row_half_mirror row_mask:0xf bank_mask:0x5
  s_nop 0
  v_add_f32_dpp v30, v29, v29 row_half_mirror row_mask:0xf bank_mask:0xa
  s_nop 1
  v_add_f32_dpp v30, v30, v30 quad_perm:[1,0,3,2] row_mask:0xf bank_mask:0xf
  s_nop 1
  v_add_f32_dpp v39, v30, v30 quad_perm:[2,3,0,1] row_mask:0xf bank_mask:0xf
  s_cmp_eq_u32 s94, 0
  s_cbranch_scc1 TH_21
  s_waitcnt vmcnt(6)
  s_cmp_lt_u32 s94, 2
  s_cbranch_scc1 TH_21
  s_waitcnt vmcnt(5)
TH_21:
  s_waitcnt vmcnt(7)
  buffer_load_dwordx4 v[116:119], v1, s[48:51], s10 offen offset:0 nt
  v_dot2_f32_bf16 v24, v176, v12, 0
  v_dot2_f32_bf16 v25, v180, v12, 0
  v_dot2_f32_bf16 v26, v184, v12, 0
  v_dot2_f32_bf16 v27, v188, v12, 0
  v_dot2_f32_bf16 v24, v177, v13, v24
  v_dot2_f32_bf16 v25, v181, v13, v25
  v_dot2_f32_bf16 v26, v185, v13, v26
  v_dot2_f32_bf16 v27, v189, v13, v27
  v_dot2_f32_bf16 v24, v178, v14, v24
  v_dot2_f32_bf16 v25, v182, v14, v25
  v_dot2_f32_bf16 v26, v186, v14, v26
  v_dot2_f32_bf16 v27, v190, v14, v27
  v_dot2_f32_bf16 v24, v179, v15, v24
  v_dot2_f32_bf16 v25, v183, v15, v25
  v_dot2_f32_bf16 v26, v187, v15, v26
  v_dot2_f32_bf16 v27, v191, v15, v27
  v_add_f32_dpp v28, v24, v24 row_ror:8 row_mask:0xf bank_mask:0x3
  v_add_f32_dpp v28, v25, v25 row_ror:8 row_mask:0xf bank_mask:0xc
  v_add_f32_dpp v29, v26, v26 row_ror:8 row_mask:0xf bank_mask:0x3
  v_add_f32_dpp v29, v27, v27 row_ror:8 row_mask:0xf bank_mask:0xc
  v_add_f32_dpp v30, v28, v28 row_half_mirror row_mask:0xf bank_mask:0x5
  s_nop 0
  v_add_f32_dpp v30, v29, v29 row_half_mirror row_mask:0xf bank_mask:0xa
  s_nop 1
  v_add_f32_dpp v30, v30, v30 quad_perm:[1,0,3,2] row_mask:0xf bank_mask:0xf
  s_nop 1
  v_add_f32_dpp v40, v30, v30 quad_perm:[2,3,0,1] row_mask:0xf bank_mask:0xf
  ds_read_b128 v[120:123], v7 offset:16384
  v_dot2_f32_bf16 v24, v192, v12, 0
  v_dot2_f32_bf16 v25, v196, v12, 0
  v_dot2_f32_bf16 v26, v200, v12, 0
  v_dot2_f32_bf16 v27, v204, v12, 0
  v_dot2_f32_bf16 v24, v193, v13, v24
  v_dot2_f32_bf16 v25, v197, v13, v25
  v_dot2_f32_bf16 v26, v201, v13, v26
  v_dot2_f32_bf16 v27, v205, v13, v27
  v_dot2_f32_bf16 v24, v194, v14, v24
  v_dot2_f32_bf16 v25, v198, v14, v25
  v_dot2_f32_bf16 v26, v202, v14, v26
  v_dot2_f32_bf16 v27, v206, v14, v27
  v_dot2_f32_bf16 v24, v195, v15, v24
  v_dot2_f32_bf16 v25, v199, v15, v25
  v_dot2_f32_bf16 v26, v203, v15, v26
  v_dot2_f32_bf16 v27, v207, v15, v27
  v_add_f32_dpp v28, v24, v24 row_ror:8 row_mask:0xf bank_mask:0x3
  v_add_f32_dpp v28, v25, v25 row_ror:8 row_mask:0xf bank_mask:0xc
  v_add_f32_dpp v29, v26, v26 row_ror:8 row_mask:0xf bank_mask:0x3
  v_add_f32_dpp v29, v27, v27 row_ror:8 row_mask:0xf bank_mask:0xc
  v_add_f32_dpp v30, v28, v28 row_half_mirror row_mask:0xf bank_mask:0x5
  s_nop 0
  v_add_f32_dpp v30, v29, v29 row_half_mirror row_mask:0xf bank_mask:0xa
  s_nop 1
  v_add_f32_dpp v30, v30, v30 quad_perm:[1,0,3,2] row_mask:0xf bank_mask:0xf
  s_nop 1
  v_add_f32_dpp v41, v30, v30 quad_perm:[2,3,0,1] row_mask:0xf bank_mask:0xf
  s_cmp_eq_u32 s94, 0
  s_cbranch_scc1 TH_22
  s_waitcnt vmcnt(6)
  s_cmp_lt_u32 s94, 2
  s_cbranch_scc1 TH_22
  s_waitcnt vmcnt(5)
TH_22:
  s_waitcnt vmcnt(7)
  buffer_load_dwordx4 v[124:127], v1, s[48:51], s10 offen offset:1024 nt
  v_dot2_f32_bf16 v24, v208, v12, 0
  v_dot2_f32_bf16 v25, v212, v12, 0
  v_dot2_f32_bf16 v26, v216, v12, 0
  v_dot2_f32_bf16 v27, v220, v12, 0
  v_dot2_f32_bf16 v24, v209, v13, v24
  v_dot2_f32_bf16 v25, v213, v13, v25
  v_dot2_f32_bf16 v26, v217, v13, v26
  v_dot2_f32_bf16 v27, v221, v13, v27
  v_dot2_f32_bf16 v24, v210, v14, v24
  v_dot2_f32_bf16 v25, v214, v14, v25
  v_dot2_f32_bf16 v26, v218, v14, v26
  v_dot2_f32_bf16 v27, v222, v14, v27
  v_dot2_f32_bf16 v24, v211, v15, v24
  v_dot2_f32_bf16 v25, v215, v15, v25
  v_dot2_f32_bf16 v26, v219, v15, v26
  v_dot2_f32_bf16 v27, v223, v15, v27
  v_add_f32_dpp v28, v24, v24 row_ror:8 row_mask:0xf bank_mask:0x3
  v_add_f32_dpp v28, v25, v25 row_ror:8 row_mask:0xf bank_mask:0xc
  v_add_f32_dpp v29, v26, v26 row_ror:8 row_mask:0xf bank_mask:0x3
  v_add_f32_dpp v29, v27, v27 row_ror:8 row_mask:0xf bank_mask:0xc
  v_add_f32_dpp v30, v28, v28 row_half_mirror row_mask:0xf bank_mask:0x5
  s_nop 0
  v_add_f32_dpp v30, v29, v29 row_half_mirror row_mask:0xf bank_mask:0xa
  s_nop 1
  v_add_f32_dpp v30, v30, v30 quad_perm:[1,0,3,2] row_mask:0xf bank_mask:0xf
  s_nop 1
  v_add_f32_dpp v42, v30, v30 quad_perm:[2,3,0,1] row_mask:0xf bank_mask:0xf
  ds_read_b128 v[128:131], v7 offset:17408
  v_dot2_f32_bf16 v24, v224, v12, 0
  v_dot2_f32_bf16 v25, v228, v12, 0
  v_dot2_f32_bf16 v26, v232, v12, 0
  v_dot2_f32_bf16 v27, v236, v12, 0
  v_dot2_f32_bf16 v24, v225, v13, v24
  v_dot2_f32_bf16 v25, v229, v13, v25
  v_dot2_f32_bf16 v26, v233, v13, v26
  v_dot2_f32_bf16 v27, v237, v13, v27
  v_dot2_f32_bf16 v24, v226, v14, v24
  v_dot2_f32_bf16 v25, v230, v14, v25
  v_dot2_f32_bf16 v26, v234, v14, v26
  v_dot2_f32_bf16 v27, v238, v14, v27
  v_dot2_f32_bf16 v24, v227, v15, v24
  v_dot2_f32_bf16 v25, v231, v15, v25
  v_dot2_f32_bf16 v26, v235, v15, v26
  v_dot2_f32_bf16 v27, v239, v15, v27
  v_add_f32_dpp v28, v24, v24 row_ror:8 row_mask:0xf bank_mask:0x3
  v_add_f32_dpp v28, v25, v25 row_ror:8 row_mask:0xf bank_mask:0xc
  v_add_f32_dpp v29, v26, v26 row_ror:8 row_mask:0xf bank_mask:0x3
  v_add_f32_dpp v29, v27, v27 row_ror:8 row_mask:0xf bank_mask:0xc
  v_add_f32_dpp v30, v28, v28 row_half_mirror row_mask:0xf bank_mask:0x5
  s_nop 0
  v_add_f32_dpp v30, v29, v29 row_half_mirror row_mask:0xf bank_mask:0xa
  s_nop 1
  v_add_f32_dpp v30, v30, v30 quad_perm:[1,0,3,2] row_mask:0xf bank_mask:0xf
  s_nop 1
  v_add_f32_dpp v43, v30, v30 quad_perm:[2,3,0,1] row_mask:0xf bank_mask:0xf
  s_cmp_eq_u32 s94, 0
  s_cbranch_scc1 TH_23
  s_waitcnt vmcnt(6)
  s_cmp_lt_u32 s94, 2
  s_cbranch_scc1 TH_23
  s_waitcnt vmcnt(5)
TH_23:
  s_waitcnt vmcnt(7)
  buffer_load_dwordx4 v[132:135], v1, s[48:51], s10 offen offset:2048 nt
  v_dot2_f32_bf16 v24, v244, v12, 0
  v_dot2_f32_bf16 v25, v248, v12, 0
  v_dot2_f32_bf16 v26, v48, v12, 0
  v_dot2_f32_bf16 v27, v52, v12, 0
  v_dot2_f32_bf16 v24, v245, v13, v24
  v_dot2_f32_bf16 v25, v249, v13, v25
  v_dot2_f32_bf16 v26, v49, v13, v26
  v_dot2_f32_bf16 v27, v53, v13, v27
  v_dot2_f32_bf16 v24, v246, v14, v24
  v_dot2_f32_bf16 v25, v250, v14, v25
  v_dot2_f32_bf16 v26, v50, v14, v26
  v_dot2_f32_bf16 v27, v54, v14, v27
  v_dot2_f32_bf16 v24, v247, v15, v24
  v_dot2_f32_bf16 v25, v251, v15, v25
  v_dot2_f32_bf16 v26, v51, v15, v26
  v_dot2_f32_bf16 v27, v55, v15, v27
  v_add_f32_dpp v28, v24, v24 row_ror:8 row_mask:0xf bank_mask:0x3
  v_add_f32_dpp v28, v25, v25 row_ror:8 row_mask:0xf bank_mask:0xc
  v_add_f32_dpp v29, v26, v26 row_ror:8 row_mask:0xf bank_mask:0x3
  v_add_f32_dpp v29, v27, v27 row_ror:8 row_mask:0xf bank_mask:0xc
  v_add_f32_dpp v30, v28, v28 row_half_mirror row_mask:0xf bank_mask:0x5
  s_nop 0
  v_add_f32_dpp v30, v29, v29 row_half_mirror row_mask:0xf bank_mask:0xa
  s_nop 1
  v_add_f32_dpp v30, v30, v30 quad_perm:[1,0,3,2] row_mask:0xf bank_mask:0xf
  s_nop 1
  v_add_f32_dpp v44, v30, v30 quad_perm:[2,3,0,1] row_mask:0xf bank_mask:0xf
  ds_read_b128 v[136:139], v7 offset:18432
  v_dot2_f32_bf16 v24, v56, v12, 0
  v_dot2_f32_bf16 v25, v60, v12, 0
  v_dot2_f32_bf16 v26, v64, v12, 0
  v_dot2_f32_bf16 v27, v72, v12, 0
  v_dot2_f32_bf16 v24, v57, v13, v24
  v_dot2_f32_bf16 v25, v61, v13, v25
  v_dot2_f32_bf16 v26, v65, v13, v26
  v_dot2_f32_bf16 v27, v73, v13, v27
  v_dot2_f32_bf16 v24, v58, v14, v24
  v_dot2_f32_bf16 v25, v62, v14, v25
  v_dot2_f32_bf16 v26, v66, v14, v26
  v_dot2_f32_bf16 v27, v74, v14, v27
  v_dot2_f32_bf16 v24, v59, v15, v24
  v_dot2_f32_bf16 v25, v63, v15, v25
  v_dot2_f32_bf16 v26, v67, v15, v26
  v_dot2_f32_bf16 v27, v75, v15, v27
  v_add_f32_dpp v28, v24, v24 row_ror:8 row_mask:0xf bank_mask:0x3
  v_add_f32_dpp v28, v25, v25 row_ror:8 row_mask:0xf bank_mask:0xc
  v_add_f32_dpp v29, v26, v26 row_ror:8 row_mask:0xf bank_mask:0x3
  v_add_f32_dpp v29, v27, v27 row_ror:8 row_mask:0xf bank_mask:0xc
  v_add_f32_dpp v30, v28, v28 row_half_mirror row_mask:0xf bank_mask:0x5
  s_nop 0
  v_add_f32_dpp v30, v29, v29 row_half_mirror row_mask:0xf bank_mask:0xa
  s_nop 1
  v_add_f32_dpp v30, v30, v30 quad_perm:[1,0,3,2] row_mask:0xf bank_mask:0xf
  s_nop 1
  v_add_f32_dpp v45, v30, v30 quad_perm:[2,3,0,1] row_mask:0xf bank_mask:0xf
  s_cmp_eq_u32 s94, 0
  s_cbranch_scc1 TH_24
  s_waitcnt vmcnt(6)
  s_cmp_lt_u32 s94, 2
  s_cbranch_scc1 TH_24
  s_waitcnt vmcnt(5)
TH_24:
  s_waitcnt vmcnt(7)
  buffer_load_dwordx4 v[140:143], v1, s[48:51], s10 offen offset:3072 nt
  s_add_u32 s10, s10, s11
  s_and_b32 s10, s10, s14
  v_dot2_f32_bf16 v24, v76, v12, 0
  v_dot2_f32_bf16 v25, v80, v12, 0
  v_dot2_f32_bf16 v26, v84, v12, 0
  v_dot2_f32_bf16 v27, v88, v12, 0
  v_dot2_f32_bf16 v24, v77, v13, v24
  v_dot2_f32_bf16 v25, v81, v13, v25
  v_dot2_f32_bf16 v26, v85, v13, v26
  v_dot2_f32_bf16 v27, v89, v13, v27
  v_dot2_f32_bf16 v24, v78, v14, v24
  v_dot2_f32_bf16 v25, v82, v14, v25
  v_dot2_f32_bf16 v26, v86, v14, v26
  v_dot2_f32_bf16 v27, v90, v14, v27
  v_dot2_f32_bf16 v24, v79, v15, v24
  v_dot2_f32_bf16 v25, v83, v15, v25
  v_dot2_f32_bf16 v26, v87, v15, v26
  v_dot2_f32_bf16 v27, v91, v15, v27
  v_add_f32_dpp v28, v24, v24 row_ror:8 row_mask:0xf bank_mask:0x3
  v_add_f32_dpp v28, v25, v25 row_ror:8 row_mask:0xf bank_mask:0xc
  v_add_f32_dpp v29, v26, v26 row_ror:8 row_mask:0xf bank_mask:0x3
  v_add_f32_dpp v29, v27, v27 row_ror:8 row_mask:0xf bank_mask:0xc
  v_add_f32_dpp v30, v28, v28 row_half_mirror row_mask:0xf bank_mask:0x5
  s_nop 0
  v_add_f32_dpp v30, v29, v29 row_half_mirror row_mask:0xf bank_mask:0xa
  s_nop 1
  v_add_f32_dpp v30, v30, v30 quad_perm:[1,0,3,2] row_mask:0xf bank_mask:0xf
  s_nop 1
  v_add_f32_dpp v46, v30, v30 quad_perm:[2,3,0,1] row_mask:0xf bank_mask:0xf
  ds_read_b128 v[144:147], v7 offset:19456
  s_waitcnt lgkmcnt(0)
  v_dot2_f32_bf16 v24, v96, v12, 0
  v_dot2_f32_bf16 v25, v100, v12, 0
  v_dot2_f32_bf16 v26, v104, v12, 0
  v_dot2_f32_bf16 v27, v112, v12, 0
  v_dot2_f32_bf16 v24, v97, v13, v24
  v_dot2_f32_bf16 v25, v101, v13, v25
  v_dot2_f32_bf16 v26, v105, v13, v26
  v_dot2_f32_bf16 v27, v113, v13, v27
  v_dot2_f32_bf16 v24, v98, v14, v24
  v_dot2_f32_bf16 v25, v102, v14, v25
  v_dot2_f32_bf16 v26, v106, v14, v26
  v_dot2_f32_bf16 v27, v114, v14, v27
  v_dot2_f32_bf16 v24, v99, v15, v24
  v_dot2_f32_bf16 v25, v103, v15, v25
  v_dot2_f32_bf16 v26, v107, v15, v26
  v_dot2_f32_bf16 v27, v115, v15, v27
  v_add_f32_dpp v28, v24, v24 row_ror:8 row_mask:0xf bank_mask:0x3
  v_add_f32_dpp v28, v25, v25 row_ror:8 row_mask:0xf bank_mask:0xc
  v_add_f32_dpp v29, v26, v26 row_ror:8 row_mask:0xf bank_mask:0x3
  v_add_f32_dpp v29, v27, v27 row_ror:8 row_mask:0xf bank_mask:0xc
  v_add_f32_dpp v30, v28, v28 row_half_mirror row_mask:0xf bank_mask:0x5
  s_nop 0
  v_add_f32_dpp v30, v29, v29 row_half_mirror row_mask:0xf bank_mask:0xa
  s_nop 1
  v_add_f32_dpp v30, v30, v30 quad_perm:[1,0,3,2] row_mask:0xf bank_mask:0xf
  s_nop 1
  v_add_f32_dpp v47, v30, v30 quad_perm:[2,3,0,1] row_mask:0xf bank_mask:0xf
  s_cmp_eq_u32 s94, 0
  s_cbranch_scc1 TH_25
  s_waitcnt vmcnt(6)
  s_cmp_lt_u32 s94, 2
  s_cbranch_scc1 TH_25
  s_waitcnt vmcnt(5)
TH_25:
  s_waitcnt vmcnt(7)
  buffer_load_dwordx4 v[148:151], v1, s[48:51], s10 offen offset:0 nt
  s_mov_b64 exec, 1
  ds_add_rtn_u32 v6, v4, v5 offset:80
  s_mov_b64 exec, -1
  s_waitcnt lgkmcnt(0)
  v_readfirstlane_b32 s8, v6
  s_nop 0
  s_sub_i32 s8, s8, 4
  s_max_i32 s8, s8, 0
  s_min_i32 s8, s8, 3
  s_lshl_b32 s8, s8, 2
  s_lshr_b32 s8, s92, s8
  s_and_b32 s94, s8, 3
  v_max3_f32 v24, v32, v33, v34
  v_max3_f32 v24, v24, v35, v36
  v_max3_f32 v24, v24, v37, v38
  v_max3_f32 v24, v24, v39, v40
  v_max3_f32 v24, v24, v41, v42
  v_max3_f32 v24, v24, v43, v44
  v_max3_f32 v24, v24, v45, v46
  v_max_f32 v24, v24, v47
  s_nop 1
  v_max_f32_dpp v24, v24, v24 row_ror:4 row_mask:0xf bank_mask:0xf
  s_nop 1
  v_max_f32_dpp v24, v24, v24 row_ror:8 row_mask:0xf bank_mask:0xf
  s_nop 0
  v_readlane_b32 s76, v24, 0
  v_readlane_b32 s77, v24, 16
  v_readlane_b32 s78, v24, 32
  v_readlane_b32 s79, v24, 48
  v_mov_b32 v26, s76
  v_max_f32 v26, s77, v26
  v_max_f32 v26, s78, v26
  v_max_f32 v26, s79, v26
  s_mov_b32 s13, 0x3e0293ee
  v_mul_f32 v26, s13, v26
  ds_read_b128 v[152:155], v7 offset:20480
  s_cmp_eq_u32 s94, 0
  s_cbranch_scc1 TH_26
  s_waitcnt vmcnt(6)
  s_cmp_lt_u32 s94, 2
  s_cbranch_scc1 TH_26
  s_waitcnt vmcnt(5)
TH_26:
  s_waitcnt vmcnt(7)
  buffer_load_dwordx4 v[156:159], v1, s[48:51], s10 offen offset:1024 nt
  v_fma_f32 v32, v32, s13, -v26
  v_fma_f32 v33, v33, s13, -v26
  v_fma_f32 v34, v34, s13, -v26
  v_fma_f32 v35, v35, s13, -v26
  v_fma_f32 v36, v36, s13, -v26
  v_fma_f32 v37, v37, s13, -v26
  v_fma_f32 v38, v38, s13, -v26
  v_fma_f32 v39, v39, s13, -v26
  v_fma_f32 v40, v40, s13, -v26
  v_fma_f32 v41, v41, s13, -v26
  v_fma_f32 v42, v42, s13, -v26
  v_fma_f32 v43, v43, s13, -v26
  v_fma_f32 v44, v44, s13, -v26
  v_fma_f32 v45, v45, s13, -v26
  v_fma_f32 v46, v46, s13, -v26
  v_fma_f32 v47, v47, s13, -v26
  v_exp_f32 v32, v32
  v_exp_f32 v33, v33
  v_exp_f32 v34, v34
  v_exp_f32 v35, v35
  v_exp_f32 v36, v36
  v_exp_f32 v37, v37
  v_exp_f32 v38, v38
  v_exp_f32 v39, v39
  ds_read_b128 v[160:163], v7 offset:21504
  s_cmp_eq_u32 s94, 0
  s_cbranch_scc1 TH_27
  s_waitcnt vmcnt(6)
  s_cmp_lt_u32 s94, 2
  s_cbranch_scc1 TH_27
  s_waitcnt vmcnt(5)
TH_27:
  s_waitcnt vmcnt(7)
  buffer_load_dwordx4 v[164:167], v1, s[48:51], s10 offen offset:2048 nt
  v_exp_f32 v40, v40
  v_exp_f32 v41, v41
  v_exp_f32 v42, v42
  v_exp_f32 v43, v43
  v_exp_f32 v44, v44
  v_exp_f32 v45, v45
  v_exp_f32 v46, v46
  v_exp_f32 v47, v47
  v_add_f32 v24, v32, v33
  v_add_f32 v25, v34, v35
  v_add_f32 v24, v24, v36
  v_add_f32 v25, v25, v37
  v_add_f32 v24, v24, v38
  v_add_f32 v25, v25, v39
  v_add_f32 v24, v24, v40
  v_add_f32 v25, v25, v41
  v_add_f32 v24, v24, v42
  v_add_f32 v25, v25, v43
  v_add_f32 v24, v24, v44
  v_add_f32 v25, v25, v45
  v_add_f32 v24, v24, v46
  v_add_f32 v25, v25, v47
  v_add_f32 v24, v24, v25
  ds_read_b128 v[168:171], v7 offset:22528
  s_cmp_eq_u32 s94, 0
  s_cbranch_scc1 TH_28
  s_waitcnt vmcnt(6)
  s_cmp_lt_u32 s94, 2
  s_cbranch_scc1 TH_28
  s_waitcnt vmcnt(5)
TH_28:
  s_waitcnt vmcnt(7)
  buffer_load_dwordx4 v[172:175], v1, s[48:51], s10 offen offset:3072 nt
  s_add_u32 s10, s10, s11
  s_and_b32 s10, s10, s14
  v_cvt_pk_bf16_f32 v32, v32, v32
  v_cvt_pk_bf16_f32 v33, v33, v33
  v_cvt_pk_bf16_f32 v34, v34, v34
  v_cvt_pk_bf16_f32 v35, v35, v35
  v_cvt_pk_bf16_f32 v36, v36, v36
  v_cvt_pk_bf16_f32 v37, v37, v37
  v_cvt_pk_bf16_f32 v38, v38, v38
  v_cvt_pk_bf16_f32 v39, v39, v39
  v_cvt_pk_bf16_f32 v40, v40, v40
  v_cvt_pk_bf16_f32 v41, v41, v41
  v_cvt_pk_bf16_f32 v42, v42, v42
  v_cvt_pk_bf16_f32 v43, v43, v43
  v_cvt_pk_bf16_f32 v44, v44, v44
  v_cvt_pk_bf16_f32 v45, v45, v45
  v_cvt_pk_bf16_f32 v46, v46, v46
  v_cvt_pk_bf16_f32 v47, v47, v47
  v_add_f32_dpp v24, v24, v24 row_ror:4 row_mask:0xf bank_mask:0xf
  s_nop 1
  v_add_f32_dpp v24, v24, v24 row_ror:8 row_mask:0xf bank_mask:0xf
  s_nop 0
  v_readlane_b32 s76, v24, 0
  v_readlane_b32 s77, v24, 16
  v_readlane_b32 s78, v24, 32
  v_readlane_b32 s79, v24, 48
  v_mov_b32 v27, s76
  v_add_f32 v27, s77, v27
  v_add_f32 v27, s78, v27
  v_add_f32 v27, s79, v27
  s_lshl_b32 s8, s3, 3
  v_mov_b32 v3, s8
  s_mov_b64 exec, 1
  ds_write_b64 v3, v[26:27] offset:96
  ds_add_u32 v4, v5 offset:8
  s_mov_b64 exec, -1
  v_mov_b32 v31, v26
  ds_read_b128 v[176:179], v7 offset:23552
  s_cmp_eq_u32 s94, 0
  s_cbranch_scc1 TH_29
  s_waitcnt vmcnt(6)
  s_cmp_lt_u32 s94, 2
  s_cbranch_scc1 TH_29
  s_waitcnt vmcnt(5)
TH_29:
  s_waitcnt vmcnt(7)
  buffer_load_dwordx4 v[180:183], v1, s[48:51], s10 offen offset:0 nt
  v_and_b32_dpp v16, v32, v8 row_newbcast:0 row_mask:0xf bank_mask:0xf
  v_and_b32_dpp v17, v32, v9 row_newbcast:0 row_mask:0xf bank_mask:0xf
  v_and_b32_dpp v18, v32, v10 row_newbcast:0 row_mask:0xf bank_mask:0xf
  v_and_b32_dpp v19, v32, v11 row_newbcast:0 row_mask:0xf bank_mask:0xf
  s_nop 1
  v_mfma_f32_16x16x32_bf16 v[252:255], v[16:19], v[120:123], 0
  v_and_b32_dpp v20, v32, v8 row_newbcast:8 row_mask:0xf bank_mask:0xf
  v_and_b32_dpp v21, v32, v9 row_newbcast:8 row_mask:0xf bank_mask:0xf
  v_and_b32_dpp v22, v32, v10 row_newbcast:8 row_mask:0xf bank_mask:0xf
  v_and_b32_dpp v23, v32, v11 row_newbcast:8 row_mask:0xf bank_mask:0xf
  s_nop 1
  v_mfma_f32_16x16x32_bf16 v[252:255], v[20:23], v[128:131], v[252:255]
  v_and_b32_dpp v16, v32, v8 row_newbcast:4 row_mask:0xf bank_mask:0xf
  v_and_b32_dpp v17, v32, v9 row_newbcast:4 row_mask:0xf bank_mask:0xf
  v_and_b32_dpp v18, v32, v10 row_newbcast:4 row_mask:0xf bank_mask:0xf
  v_and_b32_dpp v19, v32, v11 row_newbcast:4 row_mask:0xf bank_mask:0xf
  s_nop 1
  v_mfma_f32_16x16x32_bf16 v[252:255], v[16:19], v[136:139], v[252:255]
  v_and_b32_dpp v20, v32, v8 row_newbcast:12 row_mask:0xf bank_mask:0xf
  v_and_b32_dpp v21, v32, v9 row_newbcast:12 row_mask:0xf bank_mask:0xf
  v_and_b32_dpp v22, v32, v10 row_newbcast:12 row_mask:0xf bank_mask:0xf
  v_and_b32_dpp v23, v32, v11 row_newbcast:12 row_mask:0xf bank_mask:0xf
  s_nop 1
  v_mfma_f32_16x16x32_bf16 v[252:255], v[20:23], v[144:147], v[252:255]
  v_and_b32_dpp v16, v33, v8 row_newbcast:0 row_mask:0xf bank_mask:0xf
  v_and_b32_dpp v17, v33, v9 row_newbcast:0 row_mask:0xf bank_mask:0xf
  v_and_b32_dpp v18, v33, v10 row_newbcast:0 row_mask:0xf bank_mask:0xf
  v_and_b32_dpp v19, v33, v11 row_newbcast:0 row_mask:0xf bank_mask:0xf
  ds_read_b128 v[184:187], v7 offset:24576
  s_cmp_eq_u32 s94, 0
  s_cbranch_scc1 TH_30
  s_waitcnt vmcnt(6)
  s_cmp_lt_u32 s94, 2
  s_cbranch_scc1 TH_30
  s_waitcnt vmcnt(5)
TH_30:
  s_waitcnt vmcnt(7)
  buffer_load_dwordx4 v[188:191], v1, s[48:51], s10 offen offset:1024 nt
  s_waitcnt lgkmcnt(0)
  v_mfma_f32_16x16x32_bf16 v[252:255], v[16:19], v[152:155], v[252:255]
  v_and_b32_dpp v20, v33, v8 row_newbcast:8 row_mask:0xf bank_mask:0xf
  v_and_b32_dpp v21, v33, v9 row_newbcast:8 row_mask:0xf bank_mask:0xf
  v_and_b32_dpp v22, v33, v10 row_newbcast:8 row_mask:0xf bank_mask:0xf
  v_and_b32_dpp v23, v33, v11 row_newbcast:8 row_mask:0xf bank_mask:0xf
  s_nop 1
  v_mfma_f32_16x16x32_bf16 v[252:255], v[20:23], v[160:163], v[252:255]
  v_and_b32_dpp v16, v33, v8 row_newbcast:4 row_mask:0xf bank_mask:0xf
  v_and_b32_dpp v17, v33, v9 row_newbcast:4 row_mask:0xf bank_mask:0xf
  v_and_b32_dpp v18, v33, v10 row_newbcast:4 row_mask:0xf bank_mask:0xf
  v_and_b32_dpp v19, v33, v11 row_newbcast:4 row_mask:0xf bank_mask:0xf
  s_nop 1
  v_mfma_f32_16x16x32_bf16 v[252:255], v[16:19], v[168:171], v[252:255]
  v_and_b32_dpp v20, v33, v8 row_newbcast:12 row_mask:0xf bank_mask:0xf
  v_and_b32_dpp v21, v33, v9 row_newbcast:12 row_mask:0xf bank_mask:0xf
  v_and_b32_dpp v22, v33, v10 row_newbcast:12 row_mask:0xf bank_mask:0xf
  v_and_b32_dpp v23, v33, v11 row_newbcast:12 row_mask:0xf bank_mask:0xf
  s_nop 1
  v_mfma_f32_16x16x32_bf16 v[252:255], v[20:23], v[176:179], v[252:255]
  v_and_b32_dpp v16, v34, v8 row_newbcast:0 row_mask:0xf bank_mask:0xf
  v_and_b32_dpp v17, v34, v9 row_newbcast:0 row_mask:0xf bank_mask:0xf
  v_and_b32_dpp v18, v34, v10 row_newbcast:0 row_mask:0xf bank_mask:0xf
  v_and_b32_dpp v19, v34, v11 row_newbcast:0 row_mask:0xf bank_mask:0xf
  ds_read_b128 v[192:195], v7 offset:25600
  s_cmp_eq_u32 s94, 0
  s_cbranch_scc1 TH_31
  s_waitcnt vmcnt(6)
  s_cmp_lt_u32 s94, 2
  s_cbranch_scc1 TH_31
  s_waitcnt vmcnt(5)
TH_31:
  s_waitcnt vmcnt(7)
  buffer_load_dwordx4 v[196:199], v1, s[48:51], s10 offen offset:2048 nt
  s_mov_b64 exec, 1
  ds_add_rtn_u32 v6, v4, v5 offset:80
  s_mov_b64 exec, -1
  s_waitcnt lgkmcnt(0)
  v_readfirstlane_b32 s8, v6
  s_nop 0
  s_sub_i32 s8, s8, 8
  s_max_i32 s8, s8, 0
  s_min_i32 s8, s8, 3
  s_lshl_b32 s8, s8, 2
  s_lshr_b32 s8, s92, s8
  s_and_b32 s94, s8, 3
  v_mfma_f32_16x16x32_bf16 v[252:255], v[16:19], v[184:187], v[252:255]
  v_and_b32_dpp v20, v34, v8 row_newbcast:8 row_mask:0xf bank_mask:0xf
  v_and_b32_dpp v21, v34, v9 row_newbcast:8 row_mask:0xf bank_mask:0xf
  v_and_b32_dpp v22, v34, v10 row_newbcast:8 row_mask:0xf bank_mask:0xf
  v_and_b32_dpp v23, v34, v11 row_newbcast:8 row_mask:0xf bank_mask:0xf
  s_nop 1
  v_mfma_f32_16x16x32_bf16 v[252:255], v[20:23], v[192:195], v[252:255]
  v_and_b32_dpp v16, v34, v8 row_newbcast:4 row_mask:0xf bank_mask:0xf
  v_and_b32_dpp v17, v34, v9 row_newbcast:4 row_mask:0xf bank_mask:0xf
  v_and_b32_dpp v18, v34, v10 row_newbcast:4 row_mask:0xf bank_mask:0xf
  v_and_b32_dpp v19, v34, v11 row_newbcast:4 row_mask:0xf bank_mask:0xf
  ds_read_b128 v[200:203], v7 offset:26624
  s_cmp_eq_u32 s94, 0
  s_cbranch_scc1 TH_32
  s_waitcnt vmcnt(6)
  s_cmp_lt_u32 s94, 2
  s_cbranch_scc1 TH_32
  s_waitcnt vmcnt(5)
TH_32:
  s_waitcnt vmcnt(7)
  buffer_load_dwordx4 v[204:207], v1, s[48:51], s10 offen offset:3072 nt
  s_add_u32 s10, s10, s11
  s_and_b32 s10, s10, s14
  s_waitcnt lgkmcnt(0)
  v_mfma_f32_16x16x32_bf16 v[252:255], v[16:19], v[200:203], v[252:255]
  v_and_b32_dpp v20, v34, v8 row_newbcast:12 row_mask:0xf bank_mask:0xf
  v_and_b32_dpp v21, v34, v9 row_newbcast:12 row_mask:0xf bank_mask:0xf
  v_and_b32_dpp v22, v34, v10 row_newbcast:12 row_mask:0xf bank_mask:0xf
  v_and_b32_dpp v23, v34, v11 row_newbcast:12 row_mask:0xf bank_mask:0xf
  ds_read_b128 v[208:211], v7 offset:27648
  s_cmp_eq_u32 s94, 0
  s_cbranch_scc1 TH_33
  s_waitcnt vmcnt(6)
  s_cmp_lt_u32 s94, 2
  s_cbranch_scc1 TH_33
  s_waitcnt vmcnt(5)
TH_33:
  s_waitcnt vmcnt(7)
  buffer_load_dwordx4 v[212:215], v1, s[48:51], s10 offen offset:0 nt
  s_waitcnt lgkmcnt(0)
  v_mfma_f32_16x16x32_bf16 v[252:255], v[20:23], v[208:211], v[252:255]
  v_and_b32_dpp v16, v35, v8 row_newbcast:0 row_mask:0xf bank_mask:0xf
  v_and_b32_dpp v17, v35, v9 row_newbcast:0 row_mask:0xf bank_mask:0xf
  v_and_b32_dpp v18, v35, v10 row_newbcast:0 row_mask:0xf bank_mask:0xf
  v_and_b32_dpp v19, v35, v11 row_newbcast:0 row_mask:0xf bank_mask:0xf
  s_nop 1
  v_mfma_f32_16x16x32_bf16 v[252:255], v[16:19], v[240:243], v[252:255]
  v_and_b32_dpp v20, v35, v8 row_newbcast:8 row_mask:0xf bank_mask:0xf
  v_and_b32_dpp v21, v35, v9 row_newbcast:8 row_mask:0xf bank_mask:0xf
  v_and_b32_dpp v22, v35, v10 row_newbcast:8 row_mask:0xf bank_mask:0xf
  v_and_b32_dpp v23, v35, v11 row_newbcast:8 row_mask:0xf bank_mask:0xf
  s_nop 1
  v_mfma_f32_16x16x32_bf16 v[252:255], v[20:23], v[68:71], v[252:255]
  v_and_b32_dpp v16, v35, v8 row_newbcast:4 row_mask:0xf bank_mask:0xf
  v_and_b32_dpp v17, v35, v9 row_newbcast:4 row_mask:0xf bank_mask:0xf
  v_and_b32_dpp v18, v35, v10 row_newbcast:4 row_mask:0xf bank_mask:0xf
  v_and_b32_dpp v19, v35, v11 row_newbcast:4 row_mask:0xf bank_mask:0xf
  s_nop 1
  v_mfma_f32_16x16x32_bf16 v[252:255], v[16:19], v[92:95], v[252:255]
  v_and_b32_dpp v20, v35, v8 row_newbcast:12 row_mask:0xf bank_mask:0xf
  v_and_b32_dpp v21, v35, v9 row_newbcast:12 row_mask:0xf bank_mask:0xf
  v_and_b32_dpp v22, v35, v10 row_newbcast:12 row_mask:0xf bank_mask:0xf
  v_and_b32_dpp v23, v35, v11 row_newbcast:12 row_mask:0xf bank_mask:0xf
  s_cmp_eq_u32 s94, 0
  s_cbranch_scc1 TH_34
  s_waitcnt vmcnt(6)
  s_cmp_lt_u32 s94, 2
  s_cbranch_scc1 TH_34
  s_waitcnt vmcnt(5)
TH_34:
  s_waitcnt vmcnt(7)
  buffer_load_dwordx4 v[216:219], v1, s[48:51], s10 offen offset:1024 nt
  s_mov_b32 s7, 1048576
LW_35:
  ds_read_b32 v6, v4 offset:8
  s_waitcnt lgkmcnt(0)
  v_cmp_le_u32 vcc, 4, v6
  s_cbranch_vccnz LWd_36
  s_sub_u32 s7, s7, 1
  s_cbranch_scc0 LW_35
  s_branch L_END
LWd_36:
  ds_read_b128 v[24:27], v4 offset:128
  ds_read_b128 v[12:15], v4 offset:144
  s_waitcnt lgkmcnt(0)
  v_max3_f32 v28, v24, v26, v12
  v_max_f32 v28, v28, v14
  v_sub_f32 v24, v24, v28
  v_sub_f32 v26, v26, v28
  v_sub_f32 v12, v12, v28
  v_sub_f32 v14, v14, v28
  v_sub_f32 v31, v31, v28
  v_exp_f32 v24, v24
  v_exp_f32 v26, v26
  v_exp_f32 v12, v12
  v_exp_f32 v14, v14
  v_exp_f32 v31, v31
  v_mul_f32 v28, v24, v25
  v_fmac_f32 v28, v26, v27
  v_fmac_f32 v28, v12, v13
  v_fmac_f32 v28, v14, v15
  v_rcp_f32 v28, v28
  s_nop 0
  v_mul_f32 v31, v31, v28
  v_mfma_f32_16x16x32_bf16 v[252:255], v[20:23], v[108:111], v[252:255]
  v_and_b32_dpp v16, v36, v8 row_newbcast:0 row_mask:0xf bank_mask:0xf
  v_and_b32_dpp v17, v36, v9 row_newbcast:0 row_mask:0xf bank_mask:0xf
  v_and_b32_dpp v18, v36, v10 row_newbcast:0 row_mask:0xf bank_mask:0xf
  v_and_b32_dpp v19, v36, v11 row_newbcast:0 row_mask:0xf bank_mask:0xf
  s_nop 1
  v_mfma_f32_16x16x32_bf16 v[252:255], v[16:19], v[116:119], v[252:255]
  v_and_b32_dpp v20, v36, v8 row_newbcast:8 row_mask:0xf bank_mask:0xf
  v_and_b32_dpp v21, v36, v9 row_newbcast:8 row_mask:0xf bank_mask:0xf
  v_and_b32_dpp v22, v36, v10 row_newbcast:8 row_mask:0xf bank_mask:0xf
  v_and_b32_dpp v23, v36, v11 row_newbcast:8 row_mask:0xf bank_mask:0xf
  s_nop 1
  v_mfma_f32_16x16x32_bf16 v[252:255], v[20:23], v[124:127], v[252:255]
  v_and_b32_dpp v16, v36, v8 row_newbcast:4 row_mask:0xf bank_mask:0xf
  v_and_b32_dpp v17, v36, v9 row_newbcast:4 row_mask:0xf bank_mask:0xf
  v_and_b32_dpp v18, v36, v10 row_newbcast:4 row_mask:0xf bank_mask:0xf
  v_and_b32_dpp v19, v36, v11 row_newbcast:4 row_mask:0xf bank_mask:0xf
  s_nop 1
  v_mfma_f32_16x16x32_bf16 v[252:255], v[16:19], v[132:135], v[252:255]
  v_and_b32_dpp v20, v36, v8 row_newbcast:12 row_mask:0xf bank_mask:0xf
  v_and_b32_dpp v21, v36, v9 row_newbcast:12 row_mask:0xf bank_mask:0xf
  v_and_b32_dpp v22, v36, v10 row_newbcast:12 row_mask:0xf bank_mask:0xf
  v_and_b32_dpp v23, v36, v11 row_newbcast:12 row_mask:0xf bank_mask:0xf
  s_cmp_eq_u32 s94, 0
  s_cbranch_scc1 TH_37
  s_waitcnt vmcnt(6)
  s_cmp_lt_u32 s94, 2
  s_cbranch_scc1 TH_37
  s_waitcnt vmcnt(5)
TH_37:
  s_waitcnt vmcnt(7)
  buffer_load_dwordx4 v[220:223], v1, s[48:51], s10 offen offset:2048 nt
  v_mfma_f32_16x16x32_bf16 v[252:255], v[20:23], v[140:143], v[252:255]
  v_and_b32_dpp v16, v37, v8 row_newbcast:0 row_mask:0xf bank_mask:0xf
  v_and_b32_dpp v17, v37, v9 row_newbcast:0 row_mask:0xf bank_mask:0xf
  v_and_b32_dpp v18, v37, v10 row_newbcast:0 row_mask:0xf bank_mask:0xf
  v_and_b32_dpp v19, v37, v11 row_newbcast:0 row_mask:0xf bank_mask:0xf
  s_nop 1
  v_mfma_f32_16x16x32_bf16 v[252:255], v[16:19], v[148:151], v[252:255]
  v_and_b32_dpp v20, v37, v8 row_newbcast:8 row_mask:0xf bank_mask:0xf
  v_and_b32_dpp v21, v37, v9 row_newbcast:8 row_mask:0xf bank_mask:0xf
  v_and_b32_dpp v22, v37, v10 row_newbcast:8 row_mask:0xf bank_mask:0xf
  v_and_b32_dpp v23, v37, v11 row_newbcast:8 row_mask:0xf bank_mask:0xf
  s_nop 1
  v_mfma_f32_16x16x32_bf16 v[252:255], v[20:23], v[156:159], v[252:255]
  v_and_b32_dpp v16, v37, v8 row_newbcast:4 row_mask:0xf bank_mask:0xf
  v_and_b32_dpp v17, v37, v9 row_newbcast:4 row_mask:0xf bank_mask:0xf
  v_and_b32_dpp v18, v37, v10 row_newbcast:4 row_mask:0xf bank_mask:0xf
  v_and_b32_dpp v19, v37, v11 row_newbcast:4 row_mask:0xf bank_mask:0xf
  s_nop 1
  v_mfma_f32_16x16x32_bf16 v[252:255], v[16:19], v[164:167], v[252:255]
  v_and_b32_dpp v20, v37, v8 row_newbcast:12 row_mask:0xf bank_mask:0xf
  v_and_b32_dpp v21, v37, v9 row_newbcast:12 row_mask:0xf bank_mask:0xf
  v_and_b32_dpp v22, v37, v10 row_newbcast:12 row_mask:0xf bank_mask:0xf
  v_and_b32_dpp v23, v37, v11 row_newbcast:12 row_mask:0xf bank_mask:0xf
  s_cmp_eq_u32 s94, 0
  s_cbranch_scc1 TH_38
  s_waitcnt vmcnt(6)
  s_cmp_lt_u32 s94, 2
  s_cbranch_scc1 TH_38
  s_waitcnt vmcnt(5)
TH_38:
  s_waitcnt vmcnt(7)
  buffer_load_dwordx4 v[224:227], v1, s[48:51], s10 offen offset:3072 nt
  s_add_u32 s10, s10, s11
  s_and_b32 s10, s10, s14
  v_mfma_f32_16x16x32_bf16 v[252:255], v[20:23], v[172:175], v[252:255]
  v_and_b32_dpp v16, v38, v8 row_newbcast:0 row_mask:0xf bank_mask:0xf
  v_and_b32_dpp v17, v38, v9 row_newbcast:0 row_mask:0xf bank_mask:0xf
  v_and_b32_dpp v18, v38, v10 row_newbcast:0 row_mask:0xf bank_mask:0xf
  v_and_b32_dpp v19, v38, v11 row_newbcast:0 row_mask:0xf bank_mask:0xf
  s_cmp_eq_u32 s94, 0
  s_cbranch_scc1 TH_39
  s_waitcnt vmcnt(6)
  s_cmp_lt_u32 s94, 2
  s_cbranch_scc1 TH_39
  s_waitcnt vmcnt(5)
TH_39:
  s_waitcnt vmcnt(7)
  buffer_load_dwordx4 v[228:231], v1, s[48:51], s10 offen offset:0 nt
  s_mov_b64 exec, 1
  ds_add_rtn_u32 v6, v4, v5 offset:80
  s_mov_b64 exec, -1
  s_waitcnt lgkmcnt(0)
  v_readfirstlane_b32 s8, v6
  s_nop 0
  s_sub_i32 s8, s8, 12
  s_max_i32 s8, s8, 0
  s_min_i32 s8, s8, 3
  s_lshl_b32 s8, s8, 2
  s_lshr_b32 s8, s92, s8
  s_and_b32 s94, s8, 3
  v_mfma_f32_16x16x32_bf16 v[252:255], v[16:19], v[180:183], v[252:255]
  v_and_b32_dpp v20, v38, v8 row_newbcast:8 row_mask:0xf bank_mask:0xf
  v_and_b32_dpp v21, v38, v9 row_newbcast:8 row_mask:0xf bank_mask:0xf
  v_and_b32_dpp v22, v38, v10 row_newbcast:8 row_mask:0xf bank_mask:0xf
  v_and_b32_dpp v23, v38, v11 row_newbcast:8 row_mask:0xf bank_mask:0xf
  s_cmp_eq_u32 s94, 0
  s_cbranch_scc1 TH_40
  s_waitcnt vmcnt(6)
  s_cmp_lt_u32 s94, 2
  s_cbranch_scc1 TH_40
  s_waitcnt vmcnt(5)
TH_40:
  s_waitcnt vmcnt(7)
  buffer_load_dwordx4 v[232:235], v1, s[48:51], s10 offen offset:1024 nt
  v_mfma_f32_16x16x32_bf16 v[252:255], v[20:23], v[188:191], v[252:255]
  v_and_b32_dpp v16, v38, v8 row_newbcast:4 row_mask:0xf bank_mask:0xf
  v_and_b32_dpp v17, v38, v9 row_newbcast:4 row_mask:0xf bank_mask:0xf
  v_and_b32_dpp v18, v38, v10 row_newbcast:4 row_mask:0xf bank_mask:0xf
  v_and_b32_dpp v19, v38, v11 row_newbcast:4 row_mask:0xf bank_mask:0xf
  s_cmp_eq_u32 s94, 0
  s_cbranch_scc1 TH_41
  s_waitcnt vmcnt(6)
  s_cmp_lt_u32 s94, 2
  s_cbranch_scc1 TH_41
  s_waitcnt vmcnt(5)
TH_41:
  s_waitcnt vmcnt(7)
  buffer_load_dwordx4 v[236:239], v1, s[48:51], s10 offen offset:2048 nt
  v_mfma_f32_16x16x32_bf16 v[252:255], v[16:19], v[196:199], v[252:255]
  v_and_b32_dpp v20, v38, v8 row_newbcast:12 row_mask:0xf bank_mask:0xf
  v_and_b32_dpp v21, v38, v9 row_newbcast:12 row_mask:0xf bank_mask:0xf
  v_and_b32_dpp v22, v38, v10 row_newbcast:12 row_mask:0xf bank_mask:0xf
  v_and_b32_dpp v23, v38, v11 row_newbcast:12 row_mask:0xf bank_mask:0xf
  s_cmp_eq_u32 s94, 0
  s_cbranch_scc1 TH_42
  s_waitcnt vmcnt(6)
  s_cmp_lt_u32 s94, 2
  s_cbranch_scc1 TH_42
  s_waitcnt vmcnt(5)
TH_42:
  s_waitcnt vmcnt(7)
  buffer_load_dwordx4 v[244:247], v1, s[48:51], s10 offen offset:3072 nt
  s_add_u32 s10, s10, s11
  s_and_b32 s10, s10, s14
  v_mfma_f32_16x16x32_bf16 v[252:255], v[20:23], v[204:207], v[252:255]
  v_and_b32_dpp v16, v39, v8 row_newbcast:0 row_mask:0xf bank_mask:0xf
  v_and_b32_dpp v17, v39, v9 row_newbcast:0 row_mask:0xf bank_mask:0xf
  v_and_b32_dpp v18, v39, v10 row_newbcast:0 row_mask:0xf bank_mask:0xf
  v_and_b32_dpp v19, v39, v11 row_newbcast:0 row_mask:0xf bank_mask:0xf
  s_cmp_eq_u32 s94, 0
  s_cbranch_scc1 TH_43
  s_waitcnt vmcnt(5)
  s_cmp_lt_u32 s94, 2
  s_cbranch_scc1 TH_43
  s_waitcnt vmcnt(4)
TH_43:
  s_waitcnt vmcnt(7)
  buffer_load_dwordx4 v[248:251], v1, s[48:51], s10 offen offset:0 nt
  s_setprio 3
  v_mfma_f32_16x16x32_bf16 v[252:255], v[16:19], v[212:215], v[252:255]
  v_and_b32_dpp v20, v39, v8 row_newbcast:8 row_mask:0xf bank_mask:0xf
  v_and_b32_dpp v21, v39, v9 row_newbcast:8 row_mask:0xf bank_mask:0xf
  v_and_b32_dpp v22, v39, v10 row_newbcast:8 row_mask:0xf bank_mask:0xf
  v_and_b32_dpp v23, v39, v11 row_newbcast:8 row_mask:0xf bank_mask:0xf
  s_cmp_eq_u32 s94, 0
  s_cbranch_scc1 TH_44
  s_waitcnt vmcnt(5)
  s_cmp_lt_u32 s94, 2
  s_cbranch_scc1 TH_44
  s_waitcnt vmcnt(4)
TH_44:
  s_waitcnt vmcnt(7)
  buffer_load_dwordx4 v[48:51], v1, s[48:51], s10 offen offset:1024 nt
  v_mfma_f32_16x16x32_bf16 v[252:255], v[20:23], v[216:219], v[252:255]
  v_and_b32_dpp v16, v39, v8 row_newbcast:4 row_mask:0xf bank_mask:0xf
  v_and_b32_dpp v17, v39, v9 row_newbcast:4 row_mask:0xf bank_mask:0xf
  v_and_b32_dpp v18, v39, v10 row_newbcast:4 row_mask:0xf bank_mask:0xf
  v_and_b32_dpp v19, v39, v11 row_newbcast:4 row_mask:0xf bank_mask:0xf
  s_cmp_eq_u32 s94, 0
  s_cbranch_scc1 TH_45
  s_waitcnt vmcnt(5)
  s_cmp_lt_u32 s94, 2
  s_cbranch_scc1 TH_45
  s_waitcnt vmcnt(4)
TH_45:
  s_waitcnt vmcnt(7)
  buffer_load_dwordx4 v[52:55], v1, s[48:51], s10 offen offset:2048 nt
  s_mov_b64 exec, 1
  ds_add_rtn_u32 v6, v4, v5 offset:80
  s_mov_b64 exec, -1
  s_waitcnt lgkmcnt(0)
  v_readfirstlane_b32 s8, v6
  s_nop 0
  s_sub_i32 s8, s8, 16
  s_max_i32 s8, s8, 0
  s_min_i32 s8, s8, 3
  s_lshl_b32 s8, s8, 2
  s_lshr_b32 s8, s92, s8
  s_and_b32 s94, s8, 3
  v_mfma_f32_16x16x32_bf16 v[252:255], v[16:19], v[220:223], v[252:255]
  v_and_b32_dpp v20, v39, v8 row_newbcast:12 row_mask:0xf bank_mask:0xf
  v_and_b32_dpp v21, v39, v9 row_newbcast:12 row_mask:0xf bank_mask:0xf
  v_and_b32_dpp v22, v39, v10 row_newbcast:12 row_mask:0xf bank_mask:0xf
  v_and_b32_dpp v23, v39, v11 row_newbcast:12 row_mask:0xf bank_mask:0xf
  s_cmp_eq_u32 s94, 0
  s_cbranch_scc1 TH_46
  s_waitcnt vmcnt(5)
  s_cmp_lt_u32 s94, 2
  s_cbranch_scc1 TH_46
  s_waitcnt vmcnt(4)
TH_46:
  s_waitcnt vmcnt(7)
  buffer_load_dwordx4 v[56:59], v1, s[48:51], s10 offen offset:3072 nt
  s_add_u32 s10, s10, s11
  s_and_b32 s10, s10, s14
  v_mfma_f32_16x16x32_bf16 v[252:255], v[20:23], v[224:227], v[252:255]
  v_and_b32_dpp v16, v40, v8 row_newbcast:0 row_mask:0xf bank_mask:0xf
  v_and_b32_dpp v17, v40, v9 row_newbcast:0 row_mask:0xf bank_mask:0xf
  v_and_b32_dpp v18, v40, v10 row_newbcast:0 row_mask:0xf bank_mask:0xf
  v_and_b32_dpp v19, v40, v11 row_newbcast:0 row_mask:0xf bank_mask:0xf
  s_cmp_eq_u32 s94, 0
  s_cbranch_scc1 TH_47
  s_waitcnt vmcnt(5)
  s_cmp_lt_u32 s94, 2
  s_cbranch_scc1 TH_47
  s_waitcnt vmcnt(4)
TH_47:
  s_waitcnt vmcnt(7)
  buffer_load_dwordx4 v[60:63], v1, s[48:51], s10 offen offset:0 nt
  v_mfma_f32_16x16x32_bf16 v[252:255], v[16:19], v[228:231], v[252:255]
  v_and_b32_dpp v20, v40, v8 row_newbcast:8 row_mask:0xf bank_mask:0xf
  v_and_b32_dpp v21, v40, v9 row_newbcast:8 row_mask:0xf bank_mask:0xf
  v_and_b32_dpp v22, v40, v10 row_newbcast:8 row_mask:0xf bank_mask:0xf
  v_and_b32_dpp v23, v40, v11 row_newbcast:8 row_mask:0xf bank_mask:0xf
  s_cmp_eq_u32 s94, 0
  s_cbranch_scc1 TH_48
  s_waitcnt vmcnt(5)
  s_cmp_lt_u32 s94, 2
  s_cbranch_scc1 TH_48
  s_waitcnt vmcnt(4)
TH_48:
  s_waitcnt vmcnt(7)
  buffer_load_dwordx4 v[64:67], v1, s[48:51], s10 offen offset:1024 nt
  v_mfma_f32_16x16x32_bf16 v[252:255], v[20:23], v[232:235], v[252:255]
  v_and_b32_dpp v16, v40, v8 row_newbcast:4 row_mask:0xf bank_mask:0xf
  v_and_b32_dpp v17, v40, v9 row_newbcast:4 row_mask:0xf bank_mask:0xf
  v_and_b32_dpp v18, v40, v10 row_newbcast:4 row_mask:0xf bank_mask:0xf
  v_and_b32_dpp v19, v40, v11 row_newbcast:4 row_mask:0xf bank_mask:0xf
  s_cmp_eq_u32 s94, 0
  s_cbranch_scc1 TH_49
  s_waitcnt vmcnt(5)
  s_cmp_lt_u32 s94, 2
  s_cbranch_scc1 TH_49
  s_waitcnt vmcnt(4)
TH_49:
  s_waitcnt vmcnt(7)
  buffer_load_dwordx4 v[72:75], v1, s[48:51], s10 offen offset:2048 nt
  v_mfma_f32_16x16x32_bf16 v[252:255], v[16:19], v[236:239], v[252:255]
  v_and_b32_dpp v20, v40, v8 row_newbcast:12 row_mask:0xf bank_mask:0xf
  v_and_b32_dpp v21, v40, v9 row_newbcast:12 row_mask:0xf bank_mask:0xf
  v_and_b32_dpp v22, v40, v10 row_newbcast:12 row_mask:0xf bank_mask:0xf
  v_and_b32_dpp v23, v40, v11 row_newbcast:12 row_mask:0xf bank_mask:0xf
  s_cmp_eq_u32 s94, 0
  s_cbranch_scc1 TH_50
  s_waitcnt vmcnt(5)
  s_cmp_lt_u32 s94, 2
  s_cbranch_scc1 TH_50
  s_waitcnt vmcnt(4)
TH_50:
  s_waitcnt vmcnt(7)
  buffer_load_dwordx4 v[76:79], v1, s[48:51], s10 offen offset:3072 nt
  s_add_u32 s10, s10, s11
  s_and_b32 s10, s10, s14
  v_mfma_f32_16x16x32_bf16 v[252:255], v[20:23], v[244:247], v[252:255]
  v_and_b32_dpp v16, v41, v8 row_newbcast:0 row_mask:0xf bank_mask:0xf
  v_and_b32_dpp v17, v41, v9 row_newbcast:0 row_mask:0xf bank_mask:0xf
  v_and_b32_dpp v18, v41, v10 row_newbcast:0 row_mask:0xf bank_mask:0xf
  v_and_b32_dpp v19, v41, v11 row_newbcast:0 row_mask:0xf bank_mask:0xf
  s_cmp_eq_u32 s94, 0
  s_cbranch_scc1 TH_51
  s_waitcnt vmcnt(5)
  s_cmp_lt_u32 s94, 2
  s_cbranch_scc1 TH_51
  s_waitcnt vmcnt(4)
TH_51:
  s_waitcnt vmcnt(7)
  buffer_load_dwordx4 v[80:83], v1, s[48:51], s10 offen offset:0 nt
  s_mov_b64 exec, 1
  ds_add_rtn_u32 v6, v4, v5 offset:80
  s_mov_b64 exec, -1
  s_waitcnt lgkmcnt(0)
  v_readfirstlane_b32 s8, v6
  s_nop 0
  s_sub_i32 s8, s8, 20
  s_max_i32 s8, s8, 0
  s_min_i32 s8, s8, 3
  s_lshl_b32 s8, s8, 2
  s_lshr_b32 s8, s92, s8
  s_and_b32 s94, s8, 3
  v_mfma_f32_16x16x32_bf16 v[252:255], v[16:19], v[248:251], v[252:255]
  v_and_b32_dpp v20, v41, v8 row_newbcast:8 row_mask:0xf bank_mask:0xf
  v_and_b32_dpp v21, v41, v9 row_newbcast:8 row_mask:0xf bank_mask:0xf
  v_and_b32_dpp v22, v41, v10 row_newbcast:8 row_mask:0xf bank_mask:0xf
  v_and_b32_dpp v23, v41, v11 row_newbcast:8 row_mask:0xf bank_mask:0xf
  s_cmp_eq_u32 s94, 0
  s_cbranch_scc1 TH_52
  s_waitcnt vmcnt(5)
  s_cmp_lt_u32 s94, 2
  s_cbranch_scc1 TH_52
  s_waitcnt vmcnt(4)
TH_52:
  s_waitcnt vmcnt(7)
  buffer_load_dwordx4 v[84:87], v1, s[48:51], s10 offen offset:1024 nt
  v_mfma_f32_16x16x32_bf16 v[252:255], v[20:23], v[48:51], v[252:255]
  v_and_b32_dpp v16, v41, v8 row_newbcast:4 row_mask:0xf bank_mask:0xf
  v_and_b32_dpp v17, v41, v9 row_newbcast:4 row_mask:0xf bank_mask:0xf
  v_and_b32_dpp v18, v41, v10 row_newbcast:4 row_mask:0xf bank_mask:0xf
  v_and_b32_dpp v19, v41, v11 row_newbcast:4 row_mask:0xf bank_mask:0xf
  s_cmp_eq_u32 s94, 0
  s_cbranch_scc1 TH_53
  s_waitcnt vmcnt(5)
  s_cmp_lt_u32 s94, 2
  s_cbranch_scc1 TH_53
  s_waitcnt vmcnt(4)
TH_53:
  s_waitcnt vmcnt(7)
  buffer_load_dwordx4 v[88:91], v1, s[48:51], s10 offen offset:2048 nt
  v_mfma_f32_16x16x32_bf16 v[252:255], v[16:19], v[52:55], v[252:255]
  v_and_b32_dpp v20, v41, v8 row_newbcast:12 row_mask:0xf bank_mask:0xf
  v_and_b32_dpp v21, v41, v9 row_newbcast:12 row_mask:0xf bank_mask:0xf
  v_and_b32_dpp v22, v41, v10 row_newbcast:12 row_mask:0xf bank_mask:0xf
  v_and_b32_dpp v23, v41, v11 row_newbcast:12 row_mask:0xf bank_mask:0xf
  s_cmp_eq_u32 s94, 0
  s_cbranch_scc1 TH_54
  s_waitcnt vmcnt(5)
  s_cmp_lt_u32 s94, 2
  s_cbranch_scc1 TH_54
  s_waitcnt vmcnt(4)
TH_54:
  s_waitcnt vmcnt(7)
  buffer_load_dwordx4 v[96:99], v1, s[48:51], s10 offen offset:3072 nt
  s_add_u32 s10, s10, s11
  s_and_b32 s10, s10, s14
  v_mfma_f32_16x16x32_bf16 v[252:255], v[20:23], v[56:59], v[252:255]
  v_and_b32_dpp v16, v42, v8 row_newbcast:0 row_mask:0xf bank_mask:0xf
  v_and_b32_dpp v17, v42, v9 row_newbcast:0 row_mask:0xf bank_mask:0xf
  v_and_b32_dpp v18, v42, v10 row_newbcast:0 row_mask:0xf bank_mask:0xf
  v_and_b32_dpp v19, v42, v11 row_newbcast:0 row_mask:0xf bank_mask:0xf
  s_cmp_eq_u32 s94, 0
  s_cbranch_scc1 TH_55
  s_waitcnt vmcnt(5)
  s_cmp_lt_u32 s94, 2
  s_cbranch_scc1 TH_55
  s_waitcnt vmcnt(4)
TH_55:
  s_waitcnt vmcnt(7)
  buffer_load_dwordx4 v[100:103], v1, s[48:51], s10 offen offset:0 nt
  v_mfma_f32_16x16x32_bf16 v[252:255], v[16:19], v[60:63], v[252:255]
  v_and_b32_dpp v20, v42, v8 row_newbcast:8 row_mask:0xf bank_mask:0xf
  v_and_b32_dpp v21, v42, v9 row_newbcast:8 row_mask:0xf bank_mask:0xf
  v_and_b32_dpp v22, v42, v10 row_newbcast:8 row_mask:0xf bank_mask:0xf
  v_and_b32_dpp v23, v42, v11 row_newbcast:8 row_mask:0xf bank_mask:0xf
  s_cmp_eq_u32 s94, 0
  s_cbranch_scc1 TH_56
  s_waitcnt vmcnt(5)
  s_cmp_lt_u32 s94, 2
  s_cbranch_scc1 TH_56
  s_waitcnt vmcnt(4)
TH_56:
  s_waitcnt vmcnt(7)
  buffer_load_dwordx4 v[104:107], v1, s[48:51], s10 offen offset:1024 nt
  v_mfma_f32_16x16x32_bf16 v[252:255], v[20:23], v[64:67], v[252:255]
  v_and_b32_dpp v16, v42, v8 row_newbcast:4 row_mask:0xf bank_mask:0xf
  v_and_b32_dpp v17, v42, v9 row_newbcast:4 row_mask:0xf bank_mask:0xf
  v_and_b32_dpp v18, v42, v10 row_newbcast:4 row_mask:0xf bank_mask:0xf
  v_and_b32_dpp v19, v42, v11 row_newbcast:4 row_mask:0xf bank_mask:0xf
  s_cmp_eq_u32 s94, 0
  s_cbranch_scc1 TH_57
  s_waitcnt vmcnt(5)
  s_cmp_lt_u32 s94, 2
  s_cbranch_scc1 TH_57
  s_waitcnt vmcnt(4)
TH_57:
  s_waitcnt vmcnt(7)
  buffer_load_dwordx4 v[112:115], v1, s[48:51], s10 offen offset:2048 nt
  s_mov_b64 exec, 1
  ds_add_rtn_u32 v6, v4, v5 offset:80
  s_mov_b64 exec, -1
  s_waitcnt lgkmcnt(0)
  v_readfirstlane_b32 s8, v6
  s_nop 0
  s_sub_i32 s8, s8, 24
  s_max_i32 s8, s8, 0
  s_min_i32 s8, s8, 3
  s_lshl_b32 s8, s8, 2
  s_lshr_b32 s8, s92, s8
  s_and_b32 s94, s8, 3
  v_mfma_f32_16x16x32_bf16 v[252:255], v[16:19], v[72:75], v[252:255]
  v_and_b32_dpp v20, v42, v8 row_newbcast:12 row_mask:0xf bank_mask:0xf
  v_and_b32_dpp v21, v42, v9 row_newbcast:12 row_mask:0xf bank_mask:0xf
  v_and_b32_dpp v22, v42, v10 row_newbcast:12 row_mask:0xf bank_mask:0xf
  v_and_b32_dpp v23, v42, v11 row_newbcast:12 row_mask:0xf bank_mask:0xf
  s_cmp_eq_u32 s94, 0
  s_cbranch_scc1 TH_58
  s_waitcnt vmcnt(5)
  s_cmp_lt_u32 s94, 2
  s_cbranch_scc1 TH_58
  s_waitcnt vmcnt(4)
TH_58:
  s_waitcnt vmcnt(7)
  buffer_load_dwordx4 v[120:123], v1, s[48:51], s10 offen offset:3072 nt
  s_add_u32 s10, s10, s11
  s_and_b32 s10, s10, s14
  v_mfma_f32_16x16x32_bf16 v[252:255], v[20:23], v[76:79], v[252:255]
  v_and_b32_dpp v16, v43, v8 row_newbcast:0 row_mask:0xf bank_mask:0xf
  v_and_b32_dpp v17, v43, v9 row_newbcast:0 row_mask:0xf bank_mask:0xf
  v_and_b32_dpp v18, v43, v10 row_newbcast:0 row_mask:0xf bank_mask:0xf
  v_and_b32_dpp v19, v43, v11 row_newbcast:0 row_mask:0xf bank_mask:0xf
  s_cmp_eq_u32 s94, 0
  s_cbranch_scc1 TH_59
  s_waitcnt vmcnt(5)
  s_cmp_lt_u32 s94, 2
  s_cbranch_scc1 TH_59
  s_waitcnt vmcnt(4)
TH_59:
  s_waitcnt vmcnt(7)
  buffer_load_dwordx4 v[128:131], v1, s[48:51], s10 offen offset:0 nt
  v_mfma_f32_16x16x32_bf16 v[252:255], v[16:19], v[80:83], v[252:255]
  v_and_b32_dpp v20, v43, v8 row_newbcast:8 row_mask:0xf bank_mask:0xf
  v_and_b32_dpp v21, v43, v9 row_newbcast:8 row_mask:0xf bank_mask:0xf
  v_and_b32_dpp v22, v43, v10 row_newbcast:8 row_mask:0xf bank_mask:0xf
  v_and_b32_dpp v23, v43, v11 row_newbcast:8 row_mask:0xf bank_mask:0xf
  s_cmp_eq_u32 s94, 0
  s_cbranch_scc1 TH_60
  s_waitcnt vmcnt(5)
  s_cmp_lt_u32 s94, 2
  s_cbranch_scc1 TH_60
  s_waitcnt vmcnt(4)
TH_60:
  s_waitcnt vmcnt(7)
  buffer_load_dwordx4 v[136:139], v1, s[48:51], s10 offen offset:1024 nt
  v_mfma_f32_16x16x32_bf16 v[252:255], v[20:23], v[84:87], v[252:255]
  v_and_b32_dpp v16, v43, v8 row_newbcast:4 row_mask:0xf bank_mask:0xf
  v_and_b32_dpp v17, v43, v9 row_newbcast:4 row_mask:0xf bank_mask:0xf
  v_and_b32_dpp v18, v43, v10 row_newbcast:4 row_mask:0xf bank_mask:0xf
  v_and_b32_dpp v19, v43, v11 row_newbcast:4 row_mask:0xf bank_mask:0xf
  s_cmp_eq_u32 s94, 0
  s_cbranch_scc1 TH_61
  s_waitcnt vmcnt(5)
  s_cmp_lt_u32 s94, 2
  s_cbranch_scc1 TH_61
  s_waitcnt vmcnt(4)
TH_61:
  s_waitcnt vmcnt(7)
  buffer_load_dwordx4 v[144:147], v1, s[48:51], s10 offen offset:2048 nt
  s_mov_b32 s7, 1048576
LW_62:
  ds_read_b32 v6, v4 offset:24
  s_waitcnt lgkmcnt(0)
  v_cmp_le_u32 vcc, 1, v6
  s_cbranch_vccnz LWd_63
  s_sub_u32 s7, s7, 1
  s_cbranch_scc0 LW_62
  s_branch L_END
LWd_63:
  v_readfirstlane_b32 s99, v6
  s_movk_i32 s101, 0xff
  s_bfe_u32 s100, s99, 0x10008
  s_and_b32 s99, s99, s101
  s_or_b32 s61, s99, 0x3f00
  s_lshl_b32 s61, s61, 16
  s_xor_b32 s1, s99, 0x55
  s_xor_b32 s0, s61, 0x550000
  v_mfma_f32_16x16x32_bf16 v[252:255], v[16:19], v[88:91], v[252:255]
  v_and_b32_dpp v20, v43, v8 row_newbcast:12 row_mask:0xf bank_mask:0xf
  v_and_b32_dpp v21, v43, v9 row_newbcast:12 row_mask:0xf bank_mask:0xf
  v_and_b32_dpp v22, v43, v10 row_newbcast:12 row_mask:0xf bank_mask:0xf
  v_and_b32_dpp v23, v43, v11 row_newbcast:12 row_mask:0xf bank_mask:0xf
  s_cmp_eq_u32 s94, 0
  s_cbranch_scc1 TH_64
  s_waitcnt vmcnt(5)
  s_cmp_lt_u32 s94, 2
  s_cbranch_scc1 TH_64
  s_waitcnt vmcnt(4)
TH_64:
  s_waitcnt vmcnt(7)
  buffer_load_dwordx4 v[152:155], v1, s[48:51], s10 offen offset:3072 nt
  s_add_u32 s10, s10, s11
  s_and_b32 s10, s10, s14
  v_mfma_f32_16x16x32_bf16 v[252:255], v[20:23], v[96:99], v[252:255]
  v_and_b32_dpp v16, v44, v8 row_newbcast:0 row_mask:0xf bank_mask:0xf
  v_and_b32_dpp v17, v44, v9 row_newbcast:0 row_mask:0xf bank_mask:0xf
  v_and_b32_dpp v18, v44, v10 row_newbcast:0 row_mask:0xf bank_mask:0xf
  v_and_b32_dpp v19, v44, v11 row_newbcast:0 row_mask:0xf bank_mask:0xf
  s_cmp_eq_u32 s94, 0
  s_cbranch_scc1 TH_65
  s_waitcnt vmcnt(5)
  s_cmp_lt_u32 s94, 2
  s_cbranch_scc1 TH_65
  s_waitcnt vmcnt(4)
TH_65:
  s_waitcnt vmcnt(7)
  buffer_load_dwordx4 v[160:163], v1, s[48:51], s10 offen offset:0 nt
  s_mov_b64 exec, 1
  ds_add_u32 v4, v5 offset:40
  s_mov_b64 exec, -1
  s_mov_b64 exec, 1
  ds_add_rtn_u32 v6, v4, v5 offset:80
  s_mov_b64 exec, -1
  s_waitcnt lgkmcnt(0)
  v_readfirstlane_b32 s8, v6
  s_nop 0
  s_sub_i32 s8, s8, 28
  s_max_i32 s8, s8, 0
  s_min_i32 s8, s8, 3
  s_lshl_b32 s8, s8, 2
  s_lshr_b32 s8, s92, s8
  s_and_b32 s94, s8, 3
  v_mfma_f32_16x16x32_bf16 v[252:255], v[16:19], v[100:103], v[252:255]
  v_and_b32_dpp v20, v44, v8 row_newbcast:8 row_mask:0xf bank_mask:0xf
  v_and_b32_dpp v21, v44, v9 row_newbcast:8 row_mask:0xf bank_mask:0xf
  v_and_b32_dpp v22, v44, v10 row_newbcast:8 row_mask:0xf bank_mask:0xf
  v_and_b32_dpp v23, v44, v11 row_newbcast:8 row_mask:0xf bank_mask:0xf
  s_cmp_eq_u32 s94, 0
  s_cbranch_scc1 TH_66
  s_waitcnt vmcnt(5)
  s_cmp_lt_u32 s94, 2
  s_cbranch_scc1 TH_66
  s_waitcnt vmcnt(4)
TH_66:
  s_waitcnt vmcnt(7)
  buffer_load_dwordx4 v[168:171], v1, s[48:51], s10 offen offset:1024 nt
  v_mfma_f32_16x16x32_bf16 v[252:255], v[20:23], v[104:107], v[252:255]
  v_and_b32_dpp v16, v44, v8 row_newbcast:4 row_mask:0xf bank_mask:0xf
  v_and_b32_dpp v17, v44, v9 row_newbcast:4 row_mask:0xf bank_mask:0xf
  v_and_b32_dpp v18, v44, v10 row_newbcast:4 row_mask:0xf bank_mask:0xf
  v_and_b32_dpp v19, v44, v11 row_newbcast:4 row_mask:0xf bank_mask:0xf
  s_cmp_eq_u32 s94, 0
  s_cbranch_scc1 TH_67
  s_waitcnt vmcnt(5)
  s_cmp_lt_u32 s94, 2
  s_cbranch_scc1 TH_67
  s_waitcnt vmcnt(4)
TH_67:
  s_waitcnt vmcnt(7)
  buffer_load_dwordx4 v[176:179], v1, s[48:51], s10 offen offset:2048 nt
  v_mfma_f32_16x16x32_bf16 v[252:255], v[16:19], v[112:115], v[252:255]
  v_and_b32_dpp v20, v44, v8 row_newbcast:12 row_mask:0xf bank_mask:0xf
  v_and_b32_dpp v21, v44, v9 row_newbcast:12 row_mask:0xf bank_mask:0xf
  v_and_b32_dpp v22, v44, v10 row_newbcast:12 row_mask:0xf bank_mask:0xf
  v_and_b32_dpp v23, v44, v11 row_newbcast:12 row_mask:0xf bank_mask:0xf
  s_cmp_eq_u32 s94, 0
  s_cbranch_scc1 TH_68
  s_waitcnt vmcnt(5)
  s_cmp_lt_u32 s94, 2
  s_cbranch_scc1 TH_68
  s_waitcnt vmcnt(4)
TH_68:
  s_waitcnt vmcnt(7)
  buffer_load_dwordx4 v[184:187], v1, s[48:51], s10 offen offset:3072 nt
  s_add_u32 s10, s10, s11
  s_and_b32 s10, s10, s14
  v_mfma_f32_16x16x32_bf16 v[252:255], v[20:23], v[120:123], v[252:255]
  v_and_b32_dpp v16, v45, v8 row_newbcast:0 row_mask:0xf bank_mask:0xf
  v_and_b32_dpp v17, v45, v9 row_newbcast:0 row_mask:0xf bank_mask:0xf
  v_and_b32_dpp v18, v45, v10 row_newbcast:0 row_mask:0xf bank_mask:0xf
  v_and_b32_dpp v19, v45, v11 row_newbcast:0 row_mask:0xf bank_mask:0xf
  s_cmp_eq_u32 s94, 0
  s_cbranch_scc1 TH_69
  s_waitcnt vmcnt(5)
  s_cmp_lt_u32 s94, 2
  s_cbranch_scc1 TH_69
  s_waitcnt vmcnt(4)
TH_69:
  s_waitcnt vmcnt(7)
  buffer_load_dwordx4 v[192:195], v1, s[48:51], s10 offen offset:0 nt
  s_mov_b64 exec, 1
  ds_add_u32 v4, v5 offset:60
  s_mov_b64 exec, -1
  v_mfma_f32_16x16x32_bf16 v[252:255], v[16:19], v[128:131], v[252:255]
  v_and_b32_dpp v20, v45, v8 row_newbcast:8 row_mask:0xf bank_mask:0xf
  v_and_b32_dpp v21, v45, v9 row_newbcast:8 row_mask:0xf bank_mask:0xf
  v_and_b32_dpp v22, v45, v10 row_newbcast:8 row_mask:0xf bank_mask:0xf
  v_and_b32_dpp v23, v45, v11 row_newbcast:8 row_mask:0xf bank_mask:0xf
  s_cmp_eq_u32 s94, 0
  s_cbranch_scc1 TH_70
  s_waitcnt vmcnt(5)
  s_cmp_lt_u32 s94, 2
  s_cbranch_scc1 TH_70
  s_waitcnt vmcnt(4)
TH_70:
  s_waitcnt vmcnt(7)
  buffer_load_dwordx4 v[200:203], v1, s[48:51], s10 offen offset:1024 nt
  v_and_b32 v2, 15, v0
  v_lshlrev_b32 v2, 5, v2
  v_and_b32 v3, 16, v0
  s_lshl_b32 s8, s3, 9
  s_sub_u32 s8, s8, 2048
  v_add3_u32 v2, v2, v3, s8
  v_lshlrev_b32 v3, 4, v0
  s_lshl_b32 s8, s5, 12
  s_lshl_b32 s9, s4, 9
  s_add_u32 s8, s8, s9
  s_add_u32 s8, s8, 131072
  s_cmp_eq_u32 s96, 7
  s_cselect_b32 s95, 0, s100
  v_mfma_f32_16x16x32_bf16 v[252:255], v[20:23], v[136:139], v[252:255]
  v_and_b32_dpp v16, v45, v8 row_newbcast:4 row_mask:0xf bank_mask:0xf
  v_and_b32_dpp v17, v45, v9 row_newbcast:4 row_mask:0xf bank_mask:0xf
  v_and_b32_dpp v18, v45, v10 row_newbcast:4 row_mask:0xf bank_mask:0xf
  v_and_b32_dpp v19, v45, v11 row_newbcast:4 row_mask:0xf bank_mask:0xf
  s_cmp_eq_u32 s94, 0
  s_cbranch_scc1 TH_71
  s_waitcnt vmcnt(5)
  s_cmp_lt_u32 s94, 2
  s_cbranch_scc1 TH_71
  s_waitcnt vmcnt(4)
TH_71:
  s_waitcnt vmcnt(7)
  buffer_load_dwordx4 v[208:211], v1, s[48:51], s10 offen offset:2048 nt
  s_mov_b64 exec, 1
  ds_add_u32 v4, v5 offset:36
  s_mov_b64 exec, -1
  v_mfma_f32_16x16x32_bf16 v[252:255], v[16:19], v[144:147], v[252:255]
  v_and_b32_dpp v20, v45, v8 row_newbcast:12 row_mask:0xf bank_mask:0xf
  v_and_b32_dpp v21, v45, v9 row_newbcast:12 row_mask:0xf bank_mask:0xf
  v_and_b32_dpp v22, v45, v10 row_newbcast:12 row_mask:0xf bank_mask:0xf
  v_and_b32_dpp v23, v45, v11 row_newbcast:12 row_mask:0xf bank_mask:0xf
  s_cmp_eq_u32 s94, 0
  s_cbranch_scc1 TH_72
  s_waitcnt vmcnt(5)
  s_cmp_lt_u32 s94, 2
  s_cbranch_scc1 TH_72
  s_waitcnt vmcnt(4)
TH_72:
  s_waitcnt vmcnt(7)
  buffer_load_dwordx4 v[240:243], v1, s[48:51], s10 offen offset:3072 nt
  v_mfma_f32_16x16x32_bf16 v[252:255], v[20:23], v[152:155], v[252:255]
  v_and_b32_dpp v16, v46, v8 row_newbcast:0 row_mask:0xf bank_mask:0xf
  v_and_b32_dpp v17, v46, v9 row_newbcast:0 row_mask:0xf bank_mask:0xf
  v_and_b32_dpp v18, v46, v10 row_newbcast:0 row_mask:0xf bank_mask:0xf
  v_and_b32_dpp v19, v46, v11 row_newbcast:0 row_mask:0xf bank_mask:0xf
  s_waitcnt vmcnt(7)
  s_nop 0
  v_mfma_f32_16x16x32_bf16 v[252:255], v[16:19], v[160:163], v[252:255]
  v_and_b32_dpp v20, v46, v8 row_newbcast:8 row_mask:0xf bank_mask:0xf
  v_and_b32_dpp v21, v46, v9 row_newbcast:8 row_mask:0xf bank_mask:0xf
  v_and_b32_dpp v22, v46, v10 row_newbcast:8 row_mask:0xf bank_mask:0xf
  v_and_b32_dpp v23, v46, v11 row_newbcast:8 row_mask:0xf bank_mask:0xf
  s_waitcnt vmcnt(6)
  s_nop 0
  v_mfma_f32_16x16x32_bf16 v[252:255], v[20:23], v[168:171], v[252:255]
  v_and_b32_dpp v16, v46, v8 row_newbcast:4 row_mask:0xf bank_mask:0xf
  v_and_b32_dpp v17, v46, v9 row_newbcast:4 row_mask:0xf bank_mask:0xf
  v_and_b32_dpp v18, v46, v10 row_newbcast:4 row_mask:0xf bank_mask:0xf
  v_and_b32_dpp v19, v46, v11 row_newbcast:4 row_mask:0xf bank_mask:0xf
  s_waitcnt vmcnt(5)
  s_nop 0
  v_mfma_f32_16x16x32_bf16 v[252:255], v[16:19], v[176:179], v[252:255]
  v_and_b32_dpp v20, v46, v8 row_newbcast:12 row_mask:0xf bank_mask:0xf
  v_and_b32_dpp v21, v46, v9 row_newbcast:12 row_mask:0xf bank_mask:0xf
  v_and_b32_dpp v22, v46, v10 row_newbcast:12 row_mask:0xf bank_mask:0xf
  v_and_b32_dpp v23, v46, v11 row_newbcast:12 row_mask:0xf bank_mask:0xf
  s_waitcnt vmcnt(4)
  s_nop 0
  v_mfma_f32_16x16x32_bf16 v[252:255], v[20:23], v[184:187], v[252:255]
  v_and_b32_dpp v16, v47, v8 row_newbcast:0 row_mask:0xf bank_mask:0xf
  v_and_b32_dpp v17, v47, v9 row_newbcast:0 row_mask:0xf bank_mask:0xf
  v_and_b32_dpp v18, v47, v10 row_newbcast:0 row_mask:0xf bank_mask:0xf
  v_and_b32_dpp v19, v47, v11 row_newbcast:0 row_mask:0xf bank_mask:0xf
  s_waitcnt vmcnt(3)
  s_nop 0
  v_mfma_f32_16x16x32_bf16 v[252:255], v[16:19], v[192:195], v[252:255]
  v_and_b32_dpp v20, v47, v8 row_newbcast:8 row_mask:0xf bank_mask:0xf
  v_and_b32_dpp v21, v47, v9 row_newbcast:8 row_mask:0xf bank_mask:0xf
  v_and_b32_dpp v22, v47, v10 row_newbcast:8 row_mask:0xf bank_mask:0xf
  v_and_b32_dpp v23, v47, v11 row_newbcast:8 row_mask:0xf bank_mask:0xf
  s_waitcnt vmcnt(2)
  s_nop 0
  v_mfma_f32_16x16x32_bf16 v[252:255], v[20:23], v[200:203], v[252:255]
  v_and_b32_dpp v16, v47, v8 row_newbcast:4 row_mask:0xf bank_mask:0xf
  v_and_b32_dpp v17, v47, v9 row_newbcast:4 row_mask:0xf bank_mask:0xf
  v_and_b32_dpp v18, v47, v10 row_newbcast:4 row_mask:0xf bank_mask:0xf
  v_and_b32_dpp v19, v47, v11 row_newbcast:4 row_mask:0xf bank_mask:0xf
  s_waitcnt vmcnt(1)
  s_nop 0
  v_mfma_f32_16x16x32_bf16 v[252:255], v[16:19], v[208:211], v[252:255]
  v_and_b32_dpp v20, v47, v8 row_newbcast:12 row_mask:0xf bank_mask:0xf
  v_and_b32_dpp v21, v47, v9 row_newbcast:12 row_mask:0xf bank_mask:0xf
  v_and_b32_dpp v22, v47, v10 row_newbcast:12 row_mask:0xf bank_mask:0xf
  v_and_b32_dpp v23, v47, v11 row_newbcast:12 row_mask:0xf bank_mask:0xf
  s_waitcnt vmcnt(0)
  s_nop 0
  v_mfma_f32_16x16x32_bf16 v[252:255], v[20:23], v[240:243], v[252:255]
  s_nop 7
  v_mul_f32 v24, v31, v252
  v_mul_f32 v25, v31, v253
  v_mul_f32 v26, v31, v254
  v_mul_f32 v27, v31, v255
  s_mov_b32 exec_hi, 0
  ds_write_b128 v2, v[24:27] offset:512
  s_mov_b32 exec_lo, 1
  ds_add_rtn_u32 v7, v4, v5 offset:12
  s_mov_b32 exec_lo, -1
  ds_read_b128 v[32:35], v3 offset:512
  ds_read_b128 v[36:39], v3 offset:1024
  ds_read_b128 v[40:43], v3 offset:1536
  ds_read_b128 v[44:47], v3 offset:2048
  s_waitcnt lgkmcnt(4)
  v_readfirstlane_b32 s9, v7
  s_nop 0
  s_cmp_lg_u32 s9, 3
  s_cbranch_scc1 L_SDONE
  s_waitcnt lgkmcnt(2)
  v_pk_add_f32 v[32:33], v[32:33], v[36:37]
  v_pk_add_f32 v[34:35], v[34:35], v[38:39]
  s_waitcnt lgkmcnt(0)
  v_pk_add_f32 v[40:41], v[40:41], v[44:45]
  v_pk_add_f32 v[42:43], v[42:43], v[46:47]
  v_pk_add_f32 v[32:33], v[32:33], v[40:41]
  v_pk_add_f32 v[34:35], v[34:35], v[42:43]
  v_cvt_pk_bf16_f32 v32, s61, v32
  v_cvt_pk_bf16_f32 v33, s0, v33
  v_cvt_pk_bf16_f32 v34, s61, v34
  v_cvt_pk_bf16_f32 v35, s0, v35
  s_cmp_eq_u32 s95, 0
  s_cbranch_scc1 MS_73
  buffer_store_dwordx4 v[32:35], v3, s[52:55], s8 offen
  s_branch MSd_74
MS_73:
  buffer_store_dwordx4 v[32:35], v3, s[52:55], s8 offen sc1
MSd_74:
L_SDONE:
  s_mov_b64 exec, -1
  s_waitcnt lgkmcnt(0)
W_X1_0:
  s_cbranch_execz W_X1_1
  s_cmp_lg_u32 s96, 7
  s_cbranch_scc1 L_END
  v_lshrrev_b32 v1, 4, v0
  v_and_b32 v2, 15, v0
  v_and_b32 v3, 7, v0
  v_lshrrev_b32 v6, 2, v2
  v_lshl_add_u32 v8, v1, 2, v6
  v_bfe_u32 v7, v8, 1, 2
  s_and_b32 s8, s3, 3
  v_xor_b32 v7, s8, v7
  v_lshlrev_b32 v8, 7, v8
  v_lshl_add_u32 v8, v7, 5, v8
  v_and_b32 v6, 3, v0
  v_lshl_add_u32 v8, v6, 3, v8
  v_add_u32 v14, 0x10000, v8
  v_mul_u32_u24 v9, 144, v1
  v_lshl_add_u32 v9, v3, 4, v9
  s_mov_b32 s68, s36
  s_mov_b32 s69, s37
  s_mov_b32 s70, 10240
  s_mov_b32 s71, 0x20000
  v_lshlrev_b32 v248, 3, v0
  v_lshlrev_b32 v247, 4, v0
  v_mul_u32_u24 v250, 1280, v3
  v_lshrrev_b32 v6, 1, v1
  v_lshl_add_u32 v251, v6, 2, v250
  v_lshl_add_u32 v250, v1, 1, v250
  v_and_b32 v252, 1, v1
  v_lshlrev_b32 v252, 4, v252
  v_sub_u32 v252, 16, v252
  s_lshl_b32 s8, s3, 5
  s_add_u32 s8, s8, s97
  s_lshl_b32 s42, s8, 3
  s_add_u32 s43, s42, 98304
  s_mul_i32 s6, s8, 1728
  s_add_u32 s6, s6, 262144
  s_cmp_ge_u32 s3, 5
  s_cbranch_scc1 NT4_75
  s_add_u32 s9, s42, 79872
W_X1_1:
  s_cbranch_execz W_X1_2
  buffer_load_dword v249, v251, s[52:55], s9 offen sc1
  buffer_load_dwordx4 v[212:215], v247, s[52:55], s6 offen offset:0 sc1
  buffer_load_dwordx4 v[216:219], v247, s[52:55], s6 offen offset:1024 sc1
NT4_75:
  v_lshlrev_b32 v7, 3, v0
  s_mul_i32 s8, s3, 1280
  s_add_u32 s11, s8, 98304
  s_add_u32 s8, s8, 59392
  s_add_u32 s9, s8, 10240
  buffer_load_dwordx2 v[40:41], v7, s[52:55], s8 offen offset:0 sc1
  buffer_load_dwordx2 v[42:43], v7, s[52:55], s8 offen offset:512 sc1
  s_mov_b32 exec_hi, 0
  buffer_load_dwordx2 v[44:45], v7, s[52:55], s8 offen offset:1024 sc1
  s_mov_b64 exec, -1
  buffer_load_dwordx2 v[46:47], v7, s[52:55], s9 offen offset:0 sc1
  buffer_load_dwordx2 v[48:49], v7, s[52:55], s9 offen offset:512 sc1
  s_mov_b32 exec_hi, 0
  buffer_load_dwordx2 v[50:51], v7, s[52:55], s9 offen offset:1024 sc1
  s_mov_b64 exec, -1
  buffer_load_dwordx4 v[232:235], v247, s[52:55], s11 offen sc1
  buffer_load_dword v236, v7, s[52:55], s11 offen offset:1024 sc1
  s_and_b32 s10, s3, 3
  s_lshl_b32 s8, s10, 2
  v_add_u32 v58, s8, v1
  v_lshrrev_b32 v6, 4, v58
  v_lshlrev_b32 v62, 10, v6
  v_bfe_u32 v6, v58, 1, 2
  v_lshl_add_u32 v62, v6, 8, v62
  v_bfe_u32 v6, v58, 3, 1
  v_lshl_add_u32 v62, v6, 7, v62
  v_bfe_u32 v6, v58, 1, 3
  v_xor_b32 v6, v3, v6
  v_lshl_add_u32 v62, v6, 4, v62
  v_and_b32 v6, 1, v58
  v_lshl_add_u32 v62, v6, 3, v62
W_X1_2:
  s_cbranch_execz W_X1_3
  v_lshrrev_b32 v6, 3, v2
  v_lshl_add_u32 v62, v6, 2, v62
  v_mul_u32_u24 v63, 1728, v1
  v_lshl_add_u32 v63, v3, 3, v63
  v_lshrrev_b32 v6, 3, v2
  v_mul_u32_u24 v6, 27648, v6
  v_add_u32 v63, v63, v6
  s_cmp_lt_u32 s3, 4
  s_cselect_b32 s8, 165888, 0
  s_mul_i32 s9, s10, 6912
  s_add_u32 s8, s8, s9
  s_lshl_b32 s9, s97, 6
  s_add_u32 s8, s8, s9
  s_add_u32 s8, s8, 262144
  v_add_u32 v63, s8, v63
  v_lshrrev_b32 v6, 4, v0
  v_lshlrev_b32 v13, 10, v6
  v_bfe_u32 v6, v0, 1, 2
  v_lshl_add_u32 v13, v6, 8, v13
  v_bfe_u32 v6, v0, 3, 1
  v_lshl_add_u32 v13, v6, 7, v13
  v_bfe_u32 v6, v0, 1, 3
  v_xor_b32 v6, s3, v6
  v_lshl_add_u32 v13, v6, 4, v13
  v_and_b32 v6, 1, v0
  v_lshl_add_u32 v13, v6, 3, v13
  v_mov_b32 v58, v7
  v_lshrrev_b32 v6, 3, v2
  v_lshl_add_u32 v7, v6, 2, v1
  v_xor_b32 v7, v7, v3
  v_lshlrev_b32 v12, 8, v1
  v_lshl_add_u32 v12, v6, 7, v12
  v_lshl_add_u32 v12, v7, 4, v12
  v_xor_b32 v10, 0xc0, v12
  v_mov_b32 v7, v58
  v_mov_b32 v15, s99
  s_waitcnt vmcnt(0)
  v_lshlrev_b32 v249, v252, v249
W_X1_3:
  s_cbranch_execz W_X1_4
  v_and_b32 v249, 0xffff0000, v249
  v_lshlrev_b32 v28, 16, v40
  v_and_b32 v29, 0xffff0000, v40
  v_lshlrev_b32 v16, 16, v46
  v_and_b32 v17, 0xffff0000, v46
  v_lshlrev_b32 v30, 16, v41
  v_and_b32 v31, 0xffff0000, v41
  v_lshlrev_b32 v18, 16, v47
  v_and_b32 v19, 0xffff0000, v47
  v_lshlrev_b32 v32, 16, v42
  v_and_b32 v33, 0xffff0000, v42
  v_lshlrev_b32 v20, 16, v48
  v_and_b32 v21, 0xffff0000, v48
  v_lshlrev_b32 v34, 16, v43
  v_and_b32 v35, 0xffff0000, v43
  v_lshlrev_b32 v22, 16, v49
  v_and_b32 v23, 0xffff0000, v49
  v_lshlrev_b32 v36, 16, v44
  v_and_b32 v37, 0xffff0000, v44
  v_lshlrev_b32 v24, 16, v50
  v_and_b32 v25, 0xffff0000, v50
  v_lshlrev_b32 v38, 16, v45
  v_and_b32 v39, 0xffff0000, v45
  v_lshlrev_b32 v26, 16, v51
  v_and_b32 v27, 0xffff0000, v51
  v_add_f32 v16, 1.0, v16
  v_add_f32 v17, 1.0, v17
  v_add_f32 v18, 1.0, v18
  v_add_f32 v19, 1.0, v19
  v_add_f32 v20, 1.0, v20
  v_add_f32 v21, 1.0, v21
  v_add_f32 v22, 1.0, v22
  v_add_f32 v23, 1.0, v23
  v_add_f32 v24, 1.0, v24
  v_add_f32 v25, 1.0, v25
  v_add_f32 v26, 1.0, v26
  v_add_f32 v27, 1.0, v27
  v_mov_b32 v44, 0
  v_mov_b32 v45, 0
  v_mov_b32 v54, 0
  v_mov_b32 v55, 0
  v_mov_b32 v56, 0
W_X1_4:
  s_cbranch_execz W_X1_5
  v_mov_b32 v57, 0
  v_mov_b32 v2, 0x3f80
  v_mov_b32 v3, 1.0
  s_lshl_b32 s8, s3, 5
  s_add_u32 s8, s8, s97
  s_sub_u32 s8, s8, 128
  s_cmp_ge_u32 s8, 80
  s_cbranch_scc1 L_NOT2
  s_mov_b32 s64, s16
  s_mov_b32 s65, s17
  s_mov_b32 s66, 10240
  s_mov_b32 s67, 0x20000
  v_and_b32 v255, 15, v0
  v_lshlrev_b32 v255, 2, v255
  v_and_b32 v6, 1, v1
  v_mul_u32_u24 v6, 1280, v6
  v_add_u32 v255, v255, v6
  s_mul_i32 s9, s8, 205
  s_lshr_b32 s9, s9, 12
  s_mul_i32 s9, s9, 1280
  s_lshl_b32 s10, s8, 6
  s_add_u32 s9, s9, s10
  s_add_u32 s10, s9, 49152
  buffer_load_dword v253, v255, s[64:67], s9 offen
  buffer_load_dword v254, v255, s[52:55], s10 offen sc1
  s_add_u32 s92, s9, 98304
  s_lshl_b32 s93, s8, 12
  s_add_u32 s93, s93, 540672
  v_lshrrev_b32 v6, 5, v0
  v_lshlrev_b32 v6, 4, v6
  v_sub_u32 v6, 16, v6
  s_waitcnt vmcnt(0)
  v_lshlrev_b32 v253, v6, v253
  v_and_b32 v253, 0xffff0000, v253
  v_lshlrev_b32 v254, v6, v254
  v_and_b32 v254, 0xffff0000, v254
  s_mov_b32 s7, 1048576
LW_76:
  ds_read_b32 v6, v4 offset:72
W_X1_5:
  s_cbranch_execz W_X1_6
  s_waitcnt lgkmcnt(0)
  v_cmp_le_u32 vcc, 4, v6
  s_cbranch_vccnz LWd_77
  s_sub_u32 s7, s7, 1
  s_cbranch_scc0 LW_76
  s_branch L_END
LWd_77:
  s_mov_b64 s[44:45], -1
  s_mov_b64 s[46:47], -1
  s_mov_b64 s[48:49], -1
  s_mov_b64 s[50:51], -1
  s_mov_b32 s7, 1048576
RP_78:
  s_cmp_eq_u64 s[44:45], 0
  s_cbranch_scc1 RPk_80
  buffer_load_dwordx4 v[212:215], v247, s[52:55], s93 offen offset:0 sc1
RPk_80:
  s_cmp_eq_u64 s[46:47], 0
  s_cbranch_scc1 RPk_81
  buffer_load_dwordx4 v[216:219], v247, s[52:55], s93 offen offset:1024 sc1
RPk_81:
  s_cmp_eq_u64 s[48:49], 0
  s_cbranch_scc1 RPk_82
  buffer_load_dwordx4 v[220:223], v247, s[52:55], s93 offen offset:2048 sc1
RPk_82:
  s_cmp_eq_u64 s[50:51], 0
  s_cbranch_scc1 RPk_83
  buffer_load_dwordx4 v[224:227], v247, s[52:55], s93 offen offset:3072 sc1
RPk_83:
  s_waitcnt vmcnt(0)
  v_cmp_ne_u32_sdwa s[44:45], v212, v15 src0_sel:BYTE_0 src1_sel:DWORD
  v_cmp_ne_u32_sdwa s[46:47], v216, v15 src0_sel:BYTE_0 src1_sel:DWORD
  v_cmp_ne_u32_sdwa s[48:49], v220, v15 src0_sel:BYTE_0 src1_sel:DWORD
  v_cmp_ne_u32_sdwa s[50:51], v224, v15 src0_sel:BYTE_0 src1_sel:DWORD
  s_or_b64 s[8:9], s[44:45], s[46:47]
  s_or_b64 s[12:13], s[48:49], s[50:51]
  s_or_b64 s[8:9], s[8:9], s[12:13]
  s_cbranch_scc1 RPr_84
  v_xor_b32 v164, s99, v212
  v_xor_b32 v165, s1, v213
  v_xor_b32 v166, s99, v214
  v_xor_b32 v167, s1, v215
  v_xor_b32 v168, s99, v216
  v_xor_b32 v169, s1, v217
  v_xor_b32 v170, s99, v218
  v_xor_b32 v171, s1, v219
  v_xor_b32 v172, s99, v220
  v_xor_b32 v173, s1, v221
  v_xor_b32 v174, s99, v222
  v_xor_b32 v175, s1, v223
  v_xor_b32 v176, s99, v224
  v_xor_b32 v177, s1, v225
W_X1_6:
  s_cbranch_execz W_X1_7
  v_xor_b32 v178, s99, v226
  v_xor_b32 v179, s1, v227
  v_pk_add_f32 v[228:229], v[164:165], v[168:169]
  v_pk_add_f32 v[230:231], v[166:167], v[170:171]
  v_pk_add_f32 v[232:233], v[172:173], v[176:177]
  v_pk_add_f32 v[234:235], v[174:175], v[178:179]
  v_or3_b32 v236, v164, v165, v166
  v_bitop3_b32 v236, v236, v167, s101 bitop3:0xa8
  v_cmp_ne_u32 s[44:45], 0, v236
  v_pk_add_f32 v[228:229], v[228:229], v[232:233]
  v_pk_add_f32 v[230:231], v[230:231], v[234:235]
  v_or3_b32 v237, v168, v169, v170
  v_bitop3_b32 v237, v237, v171, s101 bitop3:0xa8
  v_cmp_ne_u32 s[46:47], 0, v237
  v_permlane32_swap_b32 v228, v230
  v_permlane32_swap_b32 v229, v231
  v_pk_add_f32 v[228:229], v[228:229], v[230:231]
  v_or3_b32 v238, v172, v173, v174
  v_bitop3_b32 v238, v238, v175, s101 bitop3:0xa8
  v_cmp_ne_u32 s[48:49], 0, v238
  v_permlane16_swap_b32 v228, v229
  v_add_f32 v228, v228, v229
  v_or3_b32 v239, v176, v177, v178
  v_bitop3_b32 v239, v239, v179, s101 bitop3:0xa8
  v_cmp_ne_u32 s[50:51], 0, v239
  s_or_b64 s[8:9], s[44:45], s[46:47]
  s_or_b64 s[12:13], s[48:49], s[50:51]
  s_or_b64 s[8:9], s[8:9], s[12:13]
  s_cbranch_scc0 RPok_79
RPr_84:
  s_sub_u32 s7, s7, 1
  s_cbranch_scc0 RP_78
  s_branch L_END
RPok_79:
  v_fma_f32 v228, v254, v228, v253
  v_mov_b32 v229, v228
  s_nop 1
  v_permlane32_swap_b32 v228, v229
W_X1_7:
  s_cbranch_execz W_X1_8
  s_mov_b32 exec_hi, 0
  v_cvt_pk_bf16_f32 v228, v228, v229
  s_cmp_eq_u32 s100, 0
  s_cbranch_scc1 MS_85
  buffer_store_dword v228, v255, s[52:55], s92 offen
MSd_86:
  s_mov_b64 exec, 1
  ds_add_u32 v4, v5 offset:76
  s_mov_b64 exec, -1
L_NOT2:
  s_cmp_ge_u32 s97, 27
  s_cbranch_scc1 L_T4
  s_mov_b32 s7, 1048576
LW_87:
  ds_read_b32 v6, v4 offset:0
  s_waitcnt lgkmcnt(0)
  v_cmp_le_u32 vcc, 8, v6
  s_cbranch_vccnz LWd_88
  s_sub_u32 s7, s7, 1
  s_cbranch_scc0 LW_87
  s_branch L_END
LWd_88:
  ds_read_b64_tr_b16 v[144:145], v8 offset:16384
  ds_read_b64_tr_b16 v[146:147], v8 offset:18432
  ds_read_b64_tr_b16 v[148:149], v8 offset:20480
  ds_read_b64_tr_b16 v[150:151], v8 offset:22528
  ds_read_b64_tr_b16 v[152:153], v8 offset:24576
  ds_read_b64_tr_b16 v[154:155], v8 offset:26624
  ds_read_b64_tr_b16 v[156:157], v8 offset:28672
  ds_read_b64_tr_b16 v[158:159], v8 offset:30720
  ds_read_b64_tr_b16 v[160:161], v8 offset:32768
  ds_read_b64_tr_b16 v[162:163], v8 offset:34816
  s_waitcnt lgkmcnt(4)
  ds_read_b64_tr_b16 v[164:165], v8 offset:36864
  ds_read_b64_tr_b16 v[166:167], v8 offset:38912
  ds_read_b64_tr_b16 v[168:169], v8 offset:40960
  ds_read_b64_tr_b16 v[170:171], v8 offset:43008
  ds_read_b64_tr_b16 v[172:173], v8 offset:45056
  ds_read_b64_tr_b16 v[174:175], v8 offset:47104
W_X1_8:
  s_cbranch_execz W_X1_9
  ds_read_b64_tr_b16 v[176:177], v8 offset:49152
  ds_read_b64_tr_b16 v[178:179], v8 offset:51200
  ds_read_b64_tr_b16 v[180:181], v8 offset:53248
  ds_read_b64_tr_b16 v[182:183], v8 offset:55296
  s_waitcnt lgkmcnt(4)
  ds_read_b64_tr_b16 v[184:185], v8 offset:57344
  ds_read_b64_tr_b16 v[186:187], v8 offset:59392
  ds_read_b64_tr_b16 v[188:189], v8 offset:61440
  ds_read_b64_tr_b16 v[190:191], v8 offset:63488
W_X1_9:
  s_cbranch_execz L_WRET_X1
  s_branch L_LN
L_RQ:
  v_lshrrev_b32 v52, 3, v2
  v_mul_u32_u24 v52, 20480, v52
  v_lshl_add_u32 v52, v1, 7, v52
  v_lshl_add_u32 v52, v3, 4, v52
  s_mul_i32 s11, s42, 10240
  s_mul_i32 s9, s3, 2560
  s_add_u32 s11, s11, s9
  s_add_u32 s11, s11, 4096
  s_mul_i32 s9, s3, 20
  s_add_u32 s8, s9, 0
  v_add_u32 v53, s8, v1
  v_lshrrev_b32 v6, 4, v53
  v_lshlrev_b32 v56, 10, v6
  v_bfe_u32 v6, v53, 1, 2
  v_lshl_add_u32 v56, v6, 8, v56
  v_bfe_u32 v6, v53, 3, 1
  v_lshl_add_u32 v56, v6, 7, v56
  v_bfe_u32 v6, v53, 1, 3
  v_xor_b32 v6, v3, v6
  v_lshl_add_u32 v56, v6, 4, v56
  v_and_b32 v6, 1, v53
  v_lshl_add_u32 v56, v6, 3, v56
  s_add_u32 s8, s9, 4
  v_add_u32 v53, s8, v1
  v_lshrrev_b32 v6, 4, v53
  v_lshlrev_b32 v57, 10, v6
  v_bfe_u32 v6, v53, 1, 2
  v_lshl_add_u32 v57, v6, 8, v57
  v_bfe_u32 v6, v53, 3, 1
  v_lshl_add_u32 v57, v6, 7, v57
  v_bfe_u32 v6, v53, 1, 3
  v_xor_b32 v6, v3, v6
  v_lshl_add_u32 v57, v6, 4, v57
  v_and_b32 v6, 1, v53
  v_lshl_add_u32 v57, v6, 3, v57
  s_add_u32 s8, s9, 8
  v_add_u32 v53, s8, v1
  v_lshrrev_b32 v6, 4, v53
  v_lshlrev_b32 v58, 10, v6
  v_bfe_u32 v6, v53, 1, 2
  v_lshl_add_u32 v58, v6, 8, v58
  v_bfe_u32 v6, v53, 3, 1
  v_lshl_add_u32 v58, v6, 7, v58
  v_bfe_u32 v6, v53, 1, 3
  v_xor_b32 v6, v3, v6
  v_lshl_add_u32 v58, v6, 4, v58
  v_and_b32 v6, 1, v53
  v_lshl_add_u32 v58, v6, 3, v58
  s_add_u32 s8, s9, 12
  v_add_u32 v53, s8, v1
  v_lshrrev_b32 v6, 4, v53
  v_lshlrev_b32 v59, 10, v6
  v_bfe_u32 v6, v53, 1, 2
  v_lshl_add_u32 v59, v6, 8, v59
  v_bfe_u32 v6, v53, 3, 1
  v_lshl_add_u32 v59, v6, 7, v59
  v_bfe_u32 v6, v53, 1, 3
  v_xor_b32 v6, v3, v6
  v_lshl_add_u32 v59, v6, 4, v59
  v_and_b32 v6, 1, v53
  v_lshl_add_u32 v59, v6, 3, v59
  s_add_u32 s8, s9, 16
  v_add_u32 v53, s8, v1
  v_lshrrev_b32 v6, 4, v53
  v_lshlrev_b32 v60, 10, v6
  v_bfe_u32 v6, v53, 1, 2
  v_lshl_add_u32 v60, v6, 8, v60
  v_bfe_u32 v6, v53, 3, 1
  v_lshl_add_u32 v60, v6, 7, v60
  v_bfe_u32 v6, v53, 1, 3
  v_xor_b32 v6, v3, v6
  v_lshl_add_u32 v60, v6, 4, v60
  v_and_b32 v6, 1, v53
  v_lshl_add_u32 v60, v6, 3, v60
  v_lshrrev_b32 v6, 3, v2
  v_lshl_add_u32 v7, v6, 2, v1
  v_xor_b32 v7, v7, v3
  v_lshlrev_b32 v55, 8, v1
  v_lshl_add_u32 v55, v6, 7, v55
  v_lshl_add_u32 v55, v7, 4, v55
  v_and_b32 v54, 1, v1
  v_lshlrev_b32 v54, 1, v54
  v_lshrrev_b32 v7, 1, v1
  v_add_u32 v54, v54, v7
  v_lshlrev_b32 v54, 11, v54
  v_lshl_add_u32 v54, v2, 2, v54
  s_lshr_b32 s8, s43, 1
  s_lshl_b32 s63, s8, 13
  s_lshl_b32 s9, s42, 9
  s_add_u32 s63, s63, s9
  s_and_b32 s9, s43, 1
  s_lshl_b32 s9, s9, 8
  s_add_u32 s63, s63, s9
  s_lshl_b32 s9, s3, 6
  s_add_u32 s63, s63, s9
  s_add_u32 s63, s63, 917504
  v_cmp_le_u32 s[92:93], 32, v0
  v_and_b32 v61, 1, v0
  v_mul_u32_u24 v61, 0x55, v61
  v_xor_b32 v61, s99, v61
  s_waitcnt vmcnt(0) lgkmcnt(0)
  s_mov_b64 exec, 1
  ds_add_u32 v4, v5 offset:0
  s_mov_b64 exec, -1
  s_add_u32 s15, s15, 4
  s_mov_b32 s7, 1048576
LW_89:
  ds_read_b32 v6, v4 offset:0
  s_waitcnt lgkmcnt(0)
  v_cmp_le_u32 vcc, s15, v6
  s_cbranch_vccnz LWd_90
  s_sub_u32 s7, s7, 1
  s_cbranch_scc0 LW_89
  s_branch L_END
LWd_90:
  s_cmp_lg_u32 s3, 3
  s_cbranch_scc1 P3_91
  s_getreg_b32 s8, hwreg(HW_REG_XCC_ID, 0, 4)
  s_add_u32 s8, s8, s6
  v_mov_b32 v16, s8
  v_lshlrev_b32 v17, 2, v0
  s_lshl_b32 s8, s2, 6
  s_add_u32 s8, s8, 1179648
  s_mov_b64 exec, 0xffff
  buffer_store_dword v16, v17, s[52:55], s8 offen sc1
  s_mov_b64 exec, -1
P3_91:
  ds_read_b64_tr_b16 v[64:65], v8 offset:16384
  ds_read_b64_tr_b16 v[66:67], v8 offset:18432
  ds_read_b64_tr_b16 v[68:69], v8 offset:20480
  ds_read_b64_tr_b16 v[70:71], v8 offset:22528
  ds_read_b64_tr_b16 v[72:73], v8 offset:24576
  ds_read_b64_tr_b16 v[74:75], v8 offset:26624
  ds_read_b64_tr_b16 v[76:77], v8 offset:28672
  ds_read_b64_tr_b16 v[78:79], v8 offset:30720
  ds_read_b64_tr_b16 v[80:81], v8 offset:32768
  ds_read_b64_tr_b16 v[82:83], v8 offset:34816
  s_waitcnt lgkmcnt(4)
  ds_read_b64_tr_b16 v[84:85], v8 offset:36864
  ds_read_b64_tr_b16 v[86:87], v8 offset:38912
  ds_read_b64_tr_b16 v[88:89], v8 offset:40960
  ds_read_b64_tr_b16 v[90:91], v8 offset:43008
  ds_read_b64_tr_b16 v[92:93], v8 offset:45056
  ds_read_b64_tr_b16 v[94:95], v8 offset:47104
  ds_read_b64_tr_b16 v[96:97], v8 offset:49152
  ds_read_b64_tr_b16 v[98:99], v8 offset:51200
  ds_read_b64_tr_b16 v[100:101], v8 offset:53248
  ds_read_b64_tr_b16 v[102:103], v8 offset:55296
  s_waitcnt lgkmcnt(4)
  s_waitcnt lgkmcnt(0)
  s_mov_b64 exec, 1
  ds_add_u32 v4, v5 offset:16
  s_mov_b64 exec, -1
  s_cmp_lg_u32 s3, 0
  s_cbranch_scc1 L_QWARM
  s_lshl_b32 s8, s42, 4
  s_and_b32 s9, s43, 15
  s_add_u32 s8, s8, s9
  s_mul_i32 s8, s8, 640
  s_add_u32 s8, s8, 1310720
  s_mov_b32 s7, 1048576
LW_92:
  ds_read_b32 v6, v4 offset:44
  s_waitcnt lgkmcnt(0)
  v_cmp_le_u32 vcc, 1, v6
  s_cbranch_vccnz LWd_93
  s_sleep 4
  s_sub_u32 s7, s7, 1
  s_cbranch_scc0 LW_92
  s_branch L_END
LWd_93:
  s_mov_b32 s7, 1048576
HQ_94:
  s_buffer_load_dword s64, s[52:55], s8 offset:0 glc
  s_buffer_load_dword s65, s[52:55], s8 offset:64 glc
  s_buffer_load_dword s66, s[52:55], s8 offset:128 glc
  s_buffer_load_dword s67, s[52:55], s8 offset:192 glc
  s_buffer_load_dword s68, s[52:55], s8 offset:256 glc
  s_buffer_load_dword s69, s[52:55], s8 offset:320 glc
  s_buffer_load_dword s70, s[52:55], s8 offset:384 glc
  s_buffer_load_dword s71, s[52:55], s8 offset:448 glc
  s_buffer_load_dword s72, s[52:55], s8 offset:512 glc
  s_buffer_load_dword s73, s[52:55], s8 offset:576 glc
  s_waitcnt lgkmcnt(0)
  s_xor_b32 s64, s64, s6
  s_xor_b32 s65, s65, s6
  s_xor_b32 s66, s66, s6
  s_xor_b32 s67, s67, s6
  s_xor_b32 s68, s68, s6
  s_xor_b32 s69, s69, s6
  s_xor_b32 s70, s70, s6
  s_xor_b32 s71, s71, s6
  s_xor_b32 s72, s72, s6
  s_xor_b32 s73, s73, s6
  s_or_b64 s[64:65], s[64:65], s[66:67]
  s_or_b64 s[64:65], s[64:65], s[68:69]
  s_or_b64 s[64:65], s[64:65], s[70:71]
  s_or_b64 s[64:65], s[64:65], s[72:73]
  s_cbranch_scc0 HQok_95
  s_sleep 16
  s_sub_u32 s7, s7, 1
  s_cbranch_scc0 HQ_94
  s_branch L_END
HQok_95:
  s_mov_b64 exec, 1
  ds_add_u32 v4, v5 offset:48
  s_mov_b64 exec, -1
  s_branch L_HW
L_QWARM:
  s_cmp_lg_u32 s3, 1
  s_cbranch_scc1 QW_96
  s_mov_b32 s60, 1
  s_mov_b64 exec, 0
  s_branch W_Q_0
L_RET_Q1:
  s_mov_b32 s60, 0
  s_mov_b64 exec, -1
  s_mov_b32 s60, 1
  s_mov_b64 exec, 0
  s_branch W_G_0
L_RET_G1:
  s_mov_b32 s60, 0
  s_mov_b64 exec, -1
QW_96:
  s_cmp_lg_u32 s3, 2
  s_cbranch_scc1 QW_97
QW_97:
  s_cmp_lg_u32 s3, 3
  s_cbranch_scc1 QW_98
QW_98:
L_HW:
W_Q_0:
  s_cbranch_execz W_Q_1
  s_mov_b32 s7, 1048576
LW_99:
  ds_read_b32 v6, v4 offset:48
  s_waitcnt lgkmcnt(0)
  v_cmp_le_u32 vcc, 1, v6
  s_cbranch_vccnz LWd_100
  s_sleep 1
  s_sub_u32 s7, s7, 1
  s_cbranch_scc0 LW_99
  s_branch L_END
LWd_100:
  s_mov_b32 s7, 1048576
MGP_101:
  buffer_load_dwordx4 v[104:107], v52, s[52:55], s11 offen offset:0 sc1
  buffer_load_dwordx4 v[108:111], v52, s[52:55], s11 offen offset:512 sc1
  buffer_load_dwordx4 v[112:115], v52, s[52:55], s11 offen offset:1024 sc1
  buffer_load_dwordx4 v[116:119], v52, s[52:55], s11 offen offset:1536 sc1
  buffer_load_dwordx4 v[120:123], v52, s[52:55], s11 offen offset:2048 sc1
  s_waitcnt vmcnt(0)
  v_bitop3_b32 v105, v105, v107, s6 bitop3:0x7e
  v_bitop3_b32 v109, v109, v111, s6 bitop3:0x7e
  v_bitop3_b32 v113, v113, v115, s6 bitop3:0x7e
  v_bitop3_b32 v117, v117, v119, s6 bitop3:0x7e
  v_bitop3_b32 v121, v121, v123, s6 bitop3:0x7e
  v_or3_b32 v105, v105, v109, v113
  v_or3_b32 v105, v105, v117, v121
  v_cmp_ne_u32 vcc, 0, v105
  s_cbranch_vccz MGok_102
  s_sleep 2
  s_sub_u32 s7, s7, 1
  s_cbranch_scc0 MGP_101
  s_branch L_END
MGok_102:
  v_lshlrev_b32 v20, 16, v104
  v_and_b32 v21, 0xffff0000, v104
  v_lshlrev_b32 v22, 16, v106
  v_and_b32 v23, 0xffff0000, v106
  v_lshlrev_b32 v24, 16, v108
  v_and_b32 v25, 0xffff0000, v108
  v_lshlrev_b32 v26, 16, v110
  v_and_b32 v27, 0xffff0000, v110
W_Q_1:
  s_cbranch_execz W_Q_2
  v_lshlrev_b32 v28, 16, v112
  v_and_b32 v29, 0xffff0000, v112
  v_lshlrev_b32 v30, 16, v114
  v_and_b32 v31, 0xffff0000, v114
  v_lshlrev_b32 v32, 16, v116
  v_and_b32 v33, 0xffff0000, v116
  v_lshlrev_b32 v34, 16, v118
  v_and_b32 v35, 0xffff0000, v118
  v_lshlrev_b32 v36, 16, v120
  v_and_b32 v37, 0xffff0000, v120
  v_lshlrev_b32 v38, 16, v122
  v_and_b32 v39, 0xffff0000, v122
  v_add_f32_dpp v20, v20, v20 row_ror:8 row_mask:0xf bank_mask:0xf
  v_add_f32_dpp v21, v21, v21 row_ror:8 row_mask:0xf bank_mask:0xf
  v_add_f32_dpp v22, v22, v22 row_ror:8 row_mask:0xf bank_mask:0xf
  v_add_f32_dpp v23, v23, v23 row_ror:8 row_mask:0xf bank_mask:0xf
  v_add_f32_dpp v24, v24, v24 row_ror:8 row_mask:0xf bank_mask:0xf
  v_add_f32_dpp v25, v25, v25 row_ror:8 row_mask:0xf bank_mask:0xf
  v_add_f32_dpp v26, v26, v26 row_ror:8 row_mask:0xf bank_mask:0xf
  v_add_f32_dpp v27, v27, v27 row_ror:8 row_mask:0xf bank_mask:0xf
  v_add_f32_dpp v28, v28, v28 row_ror:8 row_mask:0xf bank_mask:0xf
  v_add_f32_dpp v29, v29, v29 row_ror:8 row_mask:0xf bank_mask:0xf
  v_add_f32_dpp v30, v30, v30 row_ror:8 row_mask:0xf bank_mask:0xf
  v_add_f32_dpp v31, v31, v31 row_ror:8 row_mask:0xf bank_mask:0xf
  v_add_f32_dpp v32, v32, v32 row_ror:8 row_mask:0xf bank_mask:0xf
  v_add_f32_dpp v33, v33, v33 row_ror:8 row_mask:0xf bank_mask:0xf
  v_add_f32_dpp v34, v34, v34 row_ror:8 row_mask:0xf bank_mask:0xf
  v_add_f32_dpp v35, v35, v35 row_ror:8 row_mask:0xf bank_mask:0xf
  v_add_f32_dpp v36, v36, v36 row_ror:8 row_mask:0xf bank_mask:0xf
  v_add_f32_dpp v37, v37, v37 row_ror:8 row_mask:0xf bank_mask:0xf
  v_add_f32_dpp v38, v38, v38 row_ror:8 row_mask:0xf bank_mask:0xf
W_Q_2:
  s_cbranch_execz W_Q_3
  v_add_f32_dpp v39, v39, v39 row_ror:8 row_mask:0xf bank_mask:0xf
  v_cvt_pk_bf16_f32 v40, v20, v21
  v_cvt_pk_bf16_f32 v41, v22, v23
  v_cvt_pk_bf16_f32 v42, v24, v25
  v_cvt_pk_bf16_f32 v43, v26, v27
  v_cvt_pk_bf16_f32 v44, v28, v29
  v_cvt_pk_bf16_f32 v45, v30, v31
  v_cvt_pk_bf16_f32 v46, v32, v33
  v_cvt_pk_bf16_f32 v47, v34, v35
  v_cvt_pk_bf16_f32 v48, v36, v37
  v_cvt_pk_bf16_f32 v49, v38, v39
  s_mov_b32 exec_lo, 0x00ff00ff
  s_mov_b32 exec_hi, 0x00ff00ff
  ds_write_b64 v56, v[40:41] offset:5120
  ds_write_b64 v57, v[42:43] offset:5120
  ds_write_b64 v58, v[44:45] offset:5120
  ds_write_b64 v59, v[46:47] offset:5120
  ds_write_b64 v60, v[48:49] offset:5120
  s_mov_b64 exec, -1
  s_waitcnt vmcnt(0) lgkmcnt(0)
  s_mov_b64 exec, 1
  ds_add_u32 v4, v5 offset:0
  s_mov_b64 exec, -1
  s_add_u32 s15, s15, 4
  s_mov_b32 s7, 1048576
LW_103:
  ds_read_b32 v6, v4 offset:0
  s_waitcnt lgkmcnt(0)
  v_cmp_le_u32 vcc, s15, v6
  s_cbranch_vccnz LWd_104
  s_sub_u32 s7, s7, 1
  s_cbranch_scc0 LW_103
  s_branch L_END
LWd_104:
  ds_read_b128 v[104:107], v55 offset:5120
W_Q_3:
  s_cbranch_execz W_Q_4
  ds_read_b128 v[108:111], v55 offset:6144
  ds_read_b128 v[112:115], v55 offset:7168
  ds_read_b128 v[116:119], v55 offset:8192
  ds_read_b128 v[120:123], v55 offset:9216
  s_waitcnt lgkmcnt(4)
  v_mfma_f32_16x16x32_bf16 v[124:127], v[104:107], v[64:67], 0
  v_mfma_f32_16x16x32_bf16 v[128:131], v[104:107], v[68:71], 0
  s_waitcnt lgkmcnt(3)
  v_mfma_f32_16x16x32_bf16 v[124:127], v[108:111], v[72:75], v[124:127]
  v_mfma_f32_16x16x32_bf16 v[128:131], v[108:111], v[76:79], v[128:131]
  s_waitcnt lgkmcnt(2)
  v_mfma_f32_16x16x32_bf16 v[124:127], v[112:115], v[80:83], v[124:127]
  v_mfma_f32_16x16x32_bf16 v[128:131], v[112:115], v[84:87], v[128:131]
  s_waitcnt lgkmcnt(1)
  v_mfma_f32_16x16x32_bf16 v[124:127], v[116:119], v[88:91], v[124:127]
  v_mfma_f32_16x16x32_bf16 v[128:131], v[116:119], v[92:95], v[128:131]
  s_waitcnt lgkmcnt(0)
  v_mfma_f32_16x16x32_bf16 v[124:127], v[120:123], v[96:99], v[124:127]
  v_mfma_f32_16x16x32_bf16 v[128:131], v[120:123], v[100:103], v[128:131]
  s_nop 7
  v_cndmask_b32 v132, v124, v130, s[92:93]
  v_cndmask_b32 v133, v125, v131, s[92:93]
  v_permlane32_swap_b32 v128, v126
  v_permlane32_swap_b32 v129, v127
  v_cndmask_b32 v134, v126, v128, s[92:93]
  v_cndmask_b32 v135, v127, v129, s[92:93]
  v_pk_add_f32 v[132:133], v[132:133], v[134:135]
  v_bfi_b32 v132, s101, v61, v132
  v_bfi_b32 v133, s101, v61, v133
  buffer_store_dword v132, v54, s[52:55], s63 offen sc1
  buffer_store_dword v133, v54, s[52:55], s63 offen offset:1024 sc1
W_Q_4:
  s_cbranch_execz L_WRET_Q
  s_branch L_ARRIVE
L_RMOD:
  s_lshl_b32 s8, s3, 1
  v_add_u32 v60, 0, v0
  v_cmp_le_u32 vcc, 160, v60
  v_subrev_u32 v61, 160, v60
  s_nop 0
  v_cndmask_b32 v60, v60, v61, vcc
  v_cndmask_b32 v61, 0, v5, vcc
  v_add_u32 v61, s8, v61
  v_lshrrev_b32 v6, 4, v60
  v_lshlrev_b32 v50, 10, v6
  v_bfe_u32 v6, v60, 1, 2
  v_lshl_add_u32 v50, v6, 8, v50
  v_bfe_u32 v6, v60, 3, 1
  v_lshl_add_u32 v50, v6, 7, v50
  v_bfe_u32 v6, v60, 1, 3
  v_xor_b32 v6, v61, v6
  v_lshl_add_u32 v50, v6, 4, v50
  v_and_b32 v6, 1, v60
  v_lshl_add_u32 v50, v6, 3, v50
  v_add_u32 v60, 64, v0
  v_cmp_le_u32 vcc, 160, v60
  v_subrev_u32 v61, 160, v60
  s_nop 0
  v_cndmask_b32 v60, v60, v61, vcc
  v_cndmask_b32 v61, 0, v5, vcc
  v_add_u32 v61, s8, v61
  v_lshrrev_b32 v6, 4, v60
  v_lshlrev_b32 v51, 10, v6
  v_bfe_u32 v6, v60, 1, 2
  v_lshl_add_u32 v51, v6, 8, v51
  v_bfe_u32 v6, v60, 3, 1
  v_lshl_add_u32 v51, v6, 7, v51
  v_bfe_u32 v6, v60, 1, 3
  v_xor_b32 v6, v61, v6
  v_lshl_add_u32 v51, v6, 4, v51
  v_and_b32 v6, 1, v60
  v_lshl_add_u32 v51, v6, 3, v51
  v_add_u32 v60, 128, v0
  v_cmp_le_u32 vcc, 160, v60
  v_subrev_u32 v61, 160, v60
  s_nop 0
  v_cndmask_b32 v60, v60, v61, vcc
  v_cndmask_b32 v61, 0, v5, vcc
  v_add_u32 v61, s8, v61
  v_lshrrev_b32 v6, 4, v60
  v_lshlrev_b32 v52, 10, v6
  v_bfe_u32 v6, v60, 1, 2
  v_lshl_add_u32 v52, v6, 8, v52
  v_bfe_u32 v6, v60, 3, 1
  v_lshl_add_u32 v52, v6, 7, v52
  v_bfe_u32 v6, v60, 1, 3
  v_xor_b32 v6, v61, v6
  v_lshl_add_u32 v52, v6, 4, v52
  v_and_b32 v6, 1, v60
  v_lshl_add_u32 v52, v6, 3, v52
  v_add_u32 v60, 192, v0
  v_cmp_le_u32 vcc, 160, v60
  v_subrev_u32 v61, 160, v60
  s_nop 0
  v_cndmask_b32 v60, v60, v61, vcc
  v_cndmask_b32 v61, 0, v5, vcc
  v_add_u32 v61, s8, v61
  v_lshrrev_b32 v6, 4, v60
  v_lshlrev_b32 v53, 10, v6
  v_bfe_u32 v6, v60, 1, 2
  v_lshl_add_u32 v53, v6, 8, v53
  v_bfe_u32 v6, v60, 3, 1
  v_lshl_add_u32 v53, v6, 7, v53
  v_bfe_u32 v6, v60, 1, 3
  v_xor_b32 v6, v61, v6
  v_lshl_add_u32 v53, v6, 4, v53
  v_and_b32 v6, 1, v60
  v_lshl_add_u32 v53, v6, 3, v53
  v_add_u32 v60, 256, v0
  v_cmp_le_u32 vcc, 160, v60
  v_subrev_u32 v61, 160, v60
  s_nop 0
  v_cndmask_b32 v60, v60, v61, vcc
  v_cndmask_b32 v61, 0, v5, vcc
  v_add_u32 v61, s8, v61
  v_lshrrev_b32 v6, 4, v60
  v_lshlrev_b32 v54, 10, v6
  v_bfe_u32 v6, v60, 1, 2
  v_lshl_add_u32 v54, v6, 8, v54
  v_bfe_u32 v6, v60, 3, 1
  v_lshl_add_u32 v54, v6, 7, v54
  v_bfe_u32 v6, v60, 1, 3
  v_xor_b32 v6, v61, v6
  v_lshl_add_u32 v54, v6, 4, v54
  v_and_b32 v6, 1, v60
  v_lshl_add_u32 v54, v6, 3, v54
  v_lshrrev_b32 v6, 3, v2
  v_lshl_add_u32 v7, v6, 2, v1
  v_xor_b32 v7, v7, v3
  v_lshlrev_b32 v55, 8, v1
  v_lshl_add_u32 v55, v6, 7, v55
  v_lshl_add_u32 v55, v7, 4, v55
  s_waitcnt vmcnt(8)
  v_lshlrev_b32 v30, 16, v20
  v_and_b32 v31, 0xffff0000, v20
  v_lshlrev_b32 v32, 16, v21
  v_and_b32 v33, 0xffff0000, v21
  v_lshlrev_b32 v34, 16, v22
  v_and_b32 v35, 0xffff0000, v22
  v_lshlrev_b32 v36, 16, v23
  v_and_b32 v37, 0xffff0000, v23
  v_lshlrev_b32 v38, 16, v24
  v_and_b32 v39, 0xffff0000, v24
  v_lshlrev_b32 v40, 16, v25
  v_and_b32 v41, 0xffff0000, v25
  v_lshlrev_b32 v42, 16, v26
  v_and_b32 v43, 0xffff0000, v26
  v_lshlrev_b32 v44, 16, v27
  v_and_b32 v45, 0xffff0000, v27
  v_lshlrev_b32 v46, 16, v28
  v_and_b32 v47, 0xffff0000, v28
  v_lshlrev_b32 v48, 16, v29
  v_and_b32 v49, 0xffff0000, v29
  v_mul_f32 v64, 0xbfb8aa3b, v30
  v_mul_f32 v65, 0xbfb8aa3b, v31
  v_mul_f32 v66, 0xbfb8aa3b, v32
  v_mul_f32 v67, 0xbfb8aa3b, v33
  v_mul_f32 v68, 0xbfb8aa3b, v34
  v_mul_f32 v69, 0xbfb8aa3b, v35
  v_mul_f32 v70, 0xbfb8aa3b, v36
  v_mul_f32 v71, 0xbfb8aa3b, v37
  v_mul_f32 v72, 0xbfb8aa3b, v38
  v_mul_f32 v73, 0xbfb8aa3b, v39
  v_mul_f32 v74, 0xbfb8aa3b, v40
  v_mul_f32 v75, 0xbfb8aa3b, v41
  v_mul_f32 v76, 0xbfb8aa3b, v42
  v_mul_f32 v77, 0xbfb8aa3b, v43
  v_mul_f32 v78, 0xbfb8aa3b, v44
  v_mul_f32 v79, 0xbfb8aa3b, v45
  v_mul_f32 v80, 0xbfb8aa3b, v46
  v_mul_f32 v81, 0xbfb8aa3b, v47
  v_mul_f32 v82, 0xbfb8aa3b, v48
  v_mul_f32 v83, 0xbfb8aa3b, v49
  v_exp_f32 v64, v64
  v_exp_f32 v65, v65
  v_exp_f32 v66, v66
  v_exp_f32 v67, v67
  v_exp_f32 v68, v68
  v_exp_f32 v69, v69
  v_exp_f32 v70, v70
  v_exp_f32 v71, v71
  v_exp_f32 v72, v72
  v_exp_f32 v73, v73
  v_exp_f32 v74, v74
  v_exp_f32 v75, v75
  v_exp_f32 v76, v76
  v_exp_f32 v77, v77
  v_exp_f32 v78, v78
  v_exp_f32 v79, v79
  v_exp_f32 v80, v80
  v_exp_f32 v81, v81
  v_exp_f32 v82, v82
  v_exp_f32 v83, v83
  v_add_f32 v64, 1.0, v64
  v_add_f32 v65, 1.0, v65
  v_add_f32 v66, 1.0, v66
  v_add_f32 v67, 1.0, v67
  v_add_f32 v68, 1.0, v68
  v_add_f32 v69, 1.0, v69
  v_add_f32 v70, 1.0, v70
  v_add_f32 v71, 1.0, v71
  v_add_f32 v72, 1.0, v72
  v_add_f32 v73, 1.0, v73
  v_add_f32 v74, 1.0, v74
  v_add_f32 v75, 1.0, v75
  v_add_f32 v76, 1.0, v76
  v_add_f32 v77, 1.0, v77
  v_add_f32 v78, 1.0, v78
  v_add_f32 v79, 1.0, v79
  v_add_f32 v80, 1.0, v80
  v_add_f32 v81, 1.0, v81
  v_add_f32 v82, 1.0, v82
  v_add_f32 v83, 1.0, v83
  v_rcp_f32 v64, v64
  v_rcp_f32 v65, v65
  v_rcp_f32 v66, v66
  v_rcp_f32 v67, v67
  v_rcp_f32 v68, v68
  v_rcp_f32 v69, v69
  v_rcp_f32 v70, v70
  v_rcp_f32 v71, v71
  v_rcp_f32 v72, v72
  v_rcp_f32 v73, v73
  v_rcp_f32 v74, v74
  v_rcp_f32 v75, v75
  v_rcp_f32 v76, v76
  v_rcp_f32 v77, v77
  v_rcp_f32 v78, v78
  v_rcp_f32 v79, v79
  v_rcp_f32 v80, v80
  v_rcp_f32 v81, v81
  v_rcp_f32 v82, v82
  v_rcp_f32 v83, v83
  v_mul_f32 v30, v30, v64
  v_mul_f32 v31, v31, v65
  v_mul_f32 v32, v32, v66
  v_mul_f32 v33, v33, v67
  v_mul_f32 v34, v34, v68
  v_mul_f32 v35, v35, v69
  v_mul_f32 v36, v36, v70
  v_mul_f32 v37, v37, v71
  v_mul_f32 v38, v38, v72
  v_mul_f32 v39, v39, v73
  v_mul_f32 v40, v40, v74
  v_mul_f32 v41, v41, v75
  v_mul_f32 v42, v42, v76
  v_mul_f32 v43, v43, v77
  v_mul_f32 v44, v44, v78
  v_mul_f32 v45, v45, v79
  v_mul_f32 v46, v46, v80
  v_mul_f32 v47, v47, v81
  v_mul_f32 v48, v48, v82
  v_mul_f32 v49, v49, v83
  v_cvt_pk_bf16_f32 v20, v30, v31
  v_cvt_pk_bf16_f32 v21, v32, v33
  v_cvt_pk_bf16_f32 v22, v34, v35
  v_cvt_pk_bf16_f32 v23, v36, v37
  v_cvt_pk_bf16_f32 v24, v38, v39
  v_cvt_pk_bf16_f32 v25, v40, v41
  v_cvt_pk_bf16_f32 v26, v42, v43
  v_cvt_pk_bf16_f32 v27, v44, v45
  v_cvt_pk_bf16_f32 v28, v46, v47
  v_cvt_pk_bf16_f32 v29, v48, v49
  ds_write_b64 v50, v[20:21] offset:5120
  ds_write_b64 v51, v[22:23] offset:5120
  ds_write_b64 v52, v[24:25] offset:5120
  ds_write_b64 v53, v[26:27] offset:5120
  ds_write_b64 v54, v[28:29] offset:5120
  s_cmp_ge_u32 s43, 10
  s_cbranch_scc1 L_NOX2
  v_lshlrev_b32 v108, 16, v96
  v_and_b32 v109, 0xffff0000, v96
  v_lshlrev_b32 v110, 16, v97
  v_and_b32 v111, 0xffff0000, v97
  v_lshlrev_b32 v112, 16, v98
  v_and_b32 v113, 0xffff0000, v98
  v_lshlrev_b32 v114, 16, v99
  v_and_b32 v115, 0xffff0000, v99
  v_lshlrev_b32 v116, 16, v100
  v_and_b32 v117, 0xffff0000, v100
  v_lshlrev_b32 v118, 16, v101
  v_and_b32 v119, 0xffff0000, v101
  v_lshlrev_b32 v120, 16, v102
  v_and_b32 v121, 0xffff0000, v102
  v_lshlrev_b32 v122, 16, v103
  v_and_b32 v123, 0xffff0000, v103
  v_lshlrev_b32 v124, 16, v104
  v_and_b32 v125, 0xffff0000, v104
  v_lshlrev_b32 v126, 16, v105
  v_and_b32 v127, 0xffff0000, v105
  v_pk_add_f32 v[96:97], v[108:109], v[110:111]
  v_pk_add_f32 v[96:97], v[96:97], v[112:113]
  v_pk_add_f32 v[96:97], v[96:97], v[114:115]
  v_pk_add_f32 v[96:97], v[96:97], v[116:117]
  v_pk_add_f32 v[96:97], v[96:97], v[118:119]
  v_pk_add_f32 v[96:97], v[96:97], v[120:121]
  v_pk_add_f32 v[96:97], v[96:97], v[122:123]
  v_pk_add_f32 v[96:97], v[96:97], v[124:125]
  v_pk_add_f32 v[96:97], v[96:97], v[126:127]
  v_add_f32 v96, v96, v97
  s_nop 1
  v_add_f32_dpp v96, v96, v96 row_ror:1 row_mask:0xf bank_mask:0xf
  s_nop 1
  v_add_f32_dpp v96, v96, v96 row_ror:2 row_mask:0xf bank_mask:0xf
  s_nop 1
  v_add_f32_dpp v96, v96, v96 row_ror:4 row_mask:0xf bank_mask:0xf
  s_nop 1
  v_add_f32_dpp v96, v96, v96 row_ror:8 row_mask:0xf bank_mask:0xf
  v_mov_b32 v97, v96
  s_nop 1
  v_permlane16_swap_b32 v96, v97
  v_add_f32 v96, v96, v97
  v_mul_f32 v98, 0x3acccccd, v96
  v_sub_f32 v108, v108, v98
  v_sub_f32 v109, v109, v98
  v_sub_f32 v110, v110, v98
  v_sub_f32 v111, v111, v98
  v_sub_f32 v112, v112, v98
  v_sub_f32 v113, v113, v98
  v_sub_f32 v114, v114, v98
  v_sub_f32 v115, v115, v98
  v_sub_f32 v116, v116, v98
  v_sub_f32 v117, v117, v98
  v_sub_f32 v118, v118, v98
  v_sub_f32 v119, v119, v98
  v_sub_f32 v120, v120, v98
  v_sub_f32 v121, v121, v98
  v_sub_f32 v122, v122, v98
  v_sub_f32 v123, v123, v98
  v_sub_f32 v124, v124, v98
  v_sub_f32 v125, v125, v98
  v_sub_f32 v126, v126, v98
  v_sub_f32 v127, v127, v98
  v_pk_mul_f32 v[96:97], v[108:109], v[108:109]
  v_pk_fma_f32 v[96:97], v[110:111], v[110:111], v[96:97]
  v_pk_fma_f32 v[96:97], v[112:113], v[112:113], v[96:97]
  v_pk_fma_f32 v[96:97], v[114:115], v[114:115], v[96:97]
  v_pk_fma_f32 v[96:97], v[116:117], v[116:117], v[96:97]
  v_pk_fma_f32 v[96:97], v[118:119], v[118:119], v[96:97]
  v_pk_fma_f32 v[96:97], v[120:121], v[120:121], v[96:97]
  v_pk_fma_f32 v[96:97], v[122:123], v[122:123], v[96:97]
  v_pk_fma_f32 v[96:97], v[124:125], v[124:125], v[96:97]
  v_pk_fma_f32 v[96:97], v[126:127], v[126:127], v[96:97]
  v_add_f32 v96, v96, v97
  s_nop 1
  v_add_f32_dpp v96, v96, v96 row_ror:1 row_mask:0xf bank_mask:0xf
  s_nop 1
  v_add_f32_dpp v96, v96, v96 row_ror:2 row_mask:0xf bank_mask:0xf
  s_nop 1
  v_add_f32_dpp v96, v96, v96 row_ror:4 row_mask:0xf bank_mask:0xf
  s_nop 1
  v_add_f32_dpp v96, v96, v96 row_ror:8 row_mask:0xf bank_mask:0xf
  v_mov_b32 v97, v96
  s_nop 1
  v_permlane16_swap_b32 v96, v97
  v_add_f32 v96, v96, v97
  v_mul_f32 v96, 0x3acccccd, v96
  v_add_f32 v96, 0x3727c5ac, v96
  v_rsq_f32 v99, v96
  v_lshrrev_b32 v6, 5, v0
  v_lshlrev_b32 v6, 3, v6
  s_lshl_b32 s8, s3, 4
  v_add_u32 v6, s8, v6
  s_mov_b32 exec_lo, 1
  s_mov_b32 exec_hi, 1
  ds_write_b64 v6, v[98:99] offset:192
  s_mov_b64 exec, -1
L_NOX2:
  s_waitcnt vmcnt(0) lgkmcnt(0)
  s_mov_b64 exec, 1
  ds_add_u32 v4, v5 offset:0
  s_mov_b64 exec, -1
  s_add_u32 s15, s15, 4
  s_mov_b32 s7, 1048576
LW_105:
  ds_read_b32 v6, v4 offset:0
  s_waitcnt lgkmcnt(0)
  v_cmp_le_u32 vcc, s15, v6
  s_cbranch_vccnz LWd_106
  s_sub_u32 s7, s7, 1
  s_cbranch_scc0 LW_105
  s_branch L_END
LWd_106:
  v_lshlrev_b32 v6, 3, v3
  ds_read_b64 v[58:59], v6 offset:192
  ds_read_b64_tr_b16 v[64:65], v8 offset:16384
  ds_read_b64_tr_b16 v[66:67], v8 offset:18432
  ds_read_b64_tr_b16 v[68:69], v8 offset:20480
  ds_read_b64_tr_b16 v[70:71], v8 offset:22528
  ds_read_b64_tr_b16 v[72:73], v8 offset:24576
  ds_read_b64_tr_b16 v[74:75], v8 offset:26624
  ds_read_b64_tr_b16 v[76:77], v8 offset:28672
  ds_read_b64_tr_b16 v[78:79], v8 offset:30720
  ds_read_b64_tr_b16 v[80:81], v8 offset:32768
  ds_read_b64_tr_b16 v[82:83], v8 offset:34816
  s_waitcnt lgkmcnt(4)
  ds_read_b64_tr_b16 v[84:85], v8 offset:36864
  ds_read_b64_tr_b16 v[86:87], v8 offset:38912
  ds_read_b64_tr_b16 v[88:89], v8 offset:40960
  ds_read_b64_tr_b16 v[90:91], v8 offset:43008
  ds_read_b64_tr_b16 v[92:93], v8 offset:45056
  ds_read_b64_tr_b16 v[94:95], v8 offset:47104
  ds_read_b64_tr_b16 v[96:97], v8 offset:49152
  ds_read_b64_tr_b16 v[98:99], v8 offset:51200
  ds_read_b64_tr_b16 v[100:101], v8 offset:53248
  ds_read_b64_tr_b16 v[102:103], v8 offset:55296
  s_waitcnt lgkmcnt(4)
  ds_read_b64_tr_b16 v[104:105], v8 offset:57344
  ds_read_b64_tr_b16 v[106:107], v8 offset:59392
  ds_read_b64_tr_b16 v[108:109], v8 offset:61440
  ds_read_b64_tr_b16 v[110:111], v8 offset:63488
  ds_read_b64_tr_b16 v[112:113], v14 offset:0
  ds_read_b64_tr_b16 v[114:115], v14 offset:2048
  ds_read_b64_tr_b16 v[116:117], v14 offset:4096
  ds_read_b64_tr_b16 v[118:119], v14 offset:6144
  ds_read_b64_tr_b16 v[120:121], v14 offset:8192
  ds_read_b64_tr_b16 v[122:123], v14 offset:10240
  s_waitcnt lgkmcnt(4)
  ds_read_b64_tr_b16 v[124:125], v14 offset:12288
  ds_read_b64_tr_b16 v[126:127], v14 offset:14336
  ds_read_b64_tr_b16 v[128:129], v14 offset:16384
  ds_read_b64_tr_b16 v[130:131], v14 offset:18432
  ds_read_b64_tr_b16 v[132:133], v14 offset:20480
  ds_read_b64_tr_b16 v[134:135], v14 offset:22528
  ds_read_b64_tr_b16 v[136:137], v14 offset:24576
  ds_read_b64_tr_b16 v[138:139], v14 offset:26624
  ds_read_b64_tr_b16 v[140:141], v14 offset:28672
  ds_read_b64_tr_b16 v[142:143], v14 offset:30720
  s_waitcnt lgkmcnt(4)
  s_waitcnt lgkmcnt(0)
  s_mov_b64 exec, 1
  ds_add_u32 v4, v5 offset:16
  s_mov_b64 exec, -1
  s_waitcnt lgkmcnt(0)
  ds_read_b128 v[184:187], v55 offset:5120
  ds_read_b128 v[188:191], v55 offset:6144
  ds_read_b128 v[192:195], v55 offset:7168
  ds_read_b128 v[196:199], v55 offset:8192
  ds_read_b128 v[200:203], v55 offset:9216
  ds_read_b128 v[204:207], v55 offset:10240
  ds_read_b128 v[208:211], v55 offset:11264
  ds_read_b128 v[212:215], v55 offset:12288
  ds_read_b128 v[216:219], v55 offset:13312
  ds_read_b128 v[220:223], v55 offset:14336
  s_waitcnt lgkmcnt(9)
  v_mfma_f32_16x16x32_bf16 v[40:43], v[64:67], v[184:187], 0
  v_mfma_f32_16x16x32_bf16 v[44:47], v[68:71], v[184:187], 0
  s_waitcnt lgkmcnt(8)
  v_mfma_f32_16x16x32_bf16 v[40:43], v[72:75], v[188:191], v[40:43]
  v_mfma_f32_16x16x32_bf16 v[44:47], v[76:79], v[188:191], v[44:47]
  s_waitcnt lgkmcnt(7)
  v_mfma_f32_16x16x32_bf16 v[40:43], v[80:83], v[192:195], v[40:43]
  v_mfma_f32_16x16x32_bf16 v[44:47], v[84:87], v[192:195], v[44:47]
  s_waitcnt lgkmcnt(6)
  v_mfma_f32_16x16x32_bf16 v[40:43], v[88:91], v[196:199], v[40:43]
  v_mfma_f32_16x16x32_bf16 v[44:47], v[92:95], v[196:199], v[44:47]
  s_waitcnt lgkmcnt(5)
  v_mfma_f32_16x16x32_bf16 v[40:43], v[96:99], v[200:203], v[40:43]
  v_mfma_f32_16x16x32_bf16 v[44:47], v[100:103], v[200:203], v[44:47]
  s_waitcnt lgkmcnt(4)
  v_mfma_f32_16x16x32_bf16 v[40:43], v[104:107], v[204:207], v[40:43]
  v_mfma_f32_16x16x32_bf16 v[44:47], v[108:111], v[204:207], v[44:47]
  s_waitcnt lgkmcnt(3)
  v_mfma_f32_16x16x32_bf16 v[40:43], v[112:115], v[208:211], v[40:43]
  v_mfma_f32_16x16x32_bf16 v[44:47], v[116:119], v[208:211], v[44:47]
  s_waitcnt lgkmcnt(2)
  v_mfma_f32_16x16x32_bf16 v[40:43], v[120:123], v[212:215], v[40:43]
  v_mfma_f32_16x16x32_bf16 v[44:47], v[124:127], v[212:215], v[44:47]
  s_waitcnt lgkmcnt(1)
  v_mfma_f32_16x16x32_bf16 v[40:43], v[128:131], v[216:219], v[40:43]
  v_mfma_f32_16x16x32_bf16 v[44:47], v[132:135], v[216:219], v[44:47]
  s_waitcnt lgkmcnt(0)
  v_mfma_f32_16x16x32_bf16 v[40:43], v[136:139], v[220:223], v[40:43]
  v_mfma_f32_16x16x32_bf16 v[44:47], v[140:143], v[220:223], v[44:47]
  s_nop 7
  v_add_f32_dpp v40, v44, v40 row_ror:8 row_mask:0xf bank_mask:0xf
  v_add_f32_dpp v41, v45, v41 row_ror:8 row_mask:0xf bank_mask:0xf
  v_add_f32_dpp v42, v46, v42 row_ror:8 row_mask:0xf bank_mask:0xf
  v_add_f32_dpp v43, v47, v43 row_ror:8 row_mask:0xf bank_mask:0xf
  s_mul_i32 s92, s42, 205
  s_lshr_b32 s92, s92, 11
  s_mul_i32 s9, s92, 10
  s_sub_u32 s93, s42, s9
  s_cmp_ge_u32 s43, 10
  s_cbranch_scc1 L_NOX3
  v_lshlrev_b32 v60, 16, v56
  v_and_b32 v61, 0xffff0000, v56
  v_lshlrev_b32 v62, 16, v57
  v_and_b32 v63, 0xffff0000, v57
  v_sub_f32 v60, v60, v58
  v_sub_f32 v61, v61, v58
  v_sub_f32 v62, v62, v58
  v_sub_f32 v63, v63, v58
  v_mul_f32 v60, v60, v59
  v_mul_f32 v61, v61, v59
  v_mul_f32 v62, v62, v59
  v_mul_f32 v63, v63, v59
  v_fma_f32 v40, v60, v40, v60
  v_fma_f32 v41, v61, v41, v61
  v_fma_f32 v42, v62, v42, v62
  v_fma_f32 v43, v63, v43, v63
L_NOX3:
  v_cvt_pk_bf16_f32 v44, v40, v41
  v_cvt_pk_bf16_f32 v46, v42, v43
  s_mov_b32 exec_lo, 0x00ff00ff
  s_mov_b32 exec_hi, 0x00ff00ff
  s_cmp_ge_u32 s92, 2
  s_cbranch_scc1 L_MODLATE
  v_mov_b32 v45, s6
  v_mov_b32 v47, s6
  v_lshlrev_b32 v6, 7, v1
  v_lshl_add_u32 v6, v2, 4, v6
  s_mul_i32 s10, s92, 20480
  s_lshl_b32 s11, s93, 11
  s_add_u32 s10, s10, s11
  s_lshl_b32 s11, s3, 9
  s_add_u32 s10, s10, s11
  s_add_u32 s10, s10, 4096
  buffer_store_dwordx4 v[44:47], v6, s[52:55], s10 offen sc1
  s_mov_b64 exec, -1
  s_cmp_lg_u32 s3, 3
  s_cbranch_scc1 P3_107
  s_getreg_b32 s8, hwreg(HW_REG_XCC_ID, 0, 4)
  s_add_u32 s8, s8, s6
  v_mov_b32 v16, s8
  v_lshlrev_b32 v17, 2, v0
  s_lshl_b32 s8, s2, 6
  s_add_u32 s8, s8, 1179648
  s_mov_b64 exec, 0xffff
  buffer_store_dword v16, v17, s[52:55], s8 offen sc1
  s_mov_b64 exec, -1
P3_107:
  s_mov_b64 exec, 1
  ds_add_rtn_u32 v6, v4, v5 offset:52
  s_mov_b64 exec, -1
  s_waitcnt lgkmcnt(0)
  v_readfirstlane_b32 s8, v6
  s_nop 0
  s_cmp_lg_u32 s8, 3
  s_cbranch_scc1 L_ARRIVE
  v_lshrrev_b32 v6, 2, v0
  v_mul_u32_u24 v6, 640, v6
  v_and_b32 v7, 3, v0
  v_lshl_add_u32 v6, v7, 4, v6
  v_mov_b32 v48, s6
  v_mov_b32 v49, s6
  v_mov_b32 v50, s6
  v_mov_b32 v51, s6
  s_cmp_ge_u32 s93, 5
  s_cselect_b32 s10, 9920, 0
  s_mul_i32 s8, s92, 5
  s_add_u32 s11, s93, s8
  s_lshl_b32 s11, s11, 6
  s_add_u32 s10, s10, s11
  s_add_u32 s10, s10, 1310720
  buffer_store_dwordx4 v[48:51], v6, s[52:55], s10 offen sc1
  s_mov_b64 exec, -1
  s_branch L_ARRIVE
L_MODLATE:
  v_mov_b32 v45, v46
  v_lshlrev_b32 v6, 7, v2
  v_lshl_add_u32 v6, v1, 3, v6
  s_lshl_b32 s10, s3, 5
  v_add_u32 v6, s10, v6
  ds_write_b64 v6, v[44:45] offset:2560
  s_mov_b64 exec, 1
  ds_add_rtn_u32 v6, v4, v5 offset:52
  s_mov_b64 exec, -1
  s_waitcnt lgkmcnt(0)
  v_readfirstlane_b32 s8, v6
  s_nop 0
  s_cmp_lg_u32 s8, 3
  s_cbranch_scc1 L_ARRIVE
  s_mul_i32 s11, s92, 10240
  s_lshl_b32 s9, s93, 7
  s_add_u32 s11, s11, s9
  s_add_u32 s11, s11, 28672
  v_lshlrev_b32 v6, 4, v0
  ds_read_b128 v[44:47], v6 offset:2560
  v_lshrrev_b32 v6, 3, v0
  v_mul_u32_u24 v6, 1280, v6
  v_lshl_add_u32 v6, v3, 4, v6
  s_waitcnt lgkmcnt(0)
  buffer_store_dwordx4 v[44:47], v6, s[52:55], s11 offen sc1
  s_waitcnt vmcnt(0)
  s_getreg_b32 s8, hwreg(HW_REG_XCC_ID, 0, 4)
  s_add_u32 s8, s8, s6
  v_mov_b32 v16, s8
  v_lshlrev_b32 v17, 2, v0
  s_lshl_b32 s8, s2, 6
  s_add_u32 s8, s8, 1179648
  s_mov_b64 exec, 0xffff
  buffer_store_dword v16, v17, s[52:55], s8 offen sc1
  s_mov_b64 exec, -1
  s_branch L_ARRIVE
L_RMLP:
  s_waitcnt vmcnt(0) lgkmcnt(0)
  s_mov_b64 exec, 1
  ds_add_u32 v4, v5 offset:0
  s_mov_b64 exec, -1
  s_add_u32 s15, s15, 4
  s_mov_b32 s7, 1048576
LW_108:
  ds_read_b32 v6, v4 offset:0
  s_waitcnt lgkmcnt(0)
  v_cmp_le_u32 vcc, s15, v6
  s_cbranch_vccnz LWd_109
  s_sub_u32 s7, s7, 1
  s_cbranch_scc0 LW_108
  s_branch L_END
LWd_109:
  s_cmp_lg_u32 s3, 3
  s_cbranch_scc1 P3_110
  s_getreg_b32 s8, hwreg(HW_REG_XCC_ID, 0, 4)
  s_add_u32 s8, s8, s6
  v_mov_b32 v16, s8
  v_lshlrev_b32 v17, 2, v0
  s_lshl_b32 s8, s2, 6
  s_add_u32 s8, s8, 1179648
  s_mov_b64 exec, 0xffff
  buffer_store_dword v16, v17, s[52:55], s8 offen sc1
  s_mov_b64 exec, -1
P3_110:
  ds_read_b64_tr_b16 v[64:65], v8 offset:16384
  ds_read_b64_tr_b16 v[66:67], v8 offset:18432
  ds_read_b64_tr_b16 v[68:69], v8 offset:20480
  ds_read_b64_tr_b16 v[70:71], v8 offset:22528
  ds_read_b64_tr_b16 v[72:73], v8 offset:24576
  ds_read_b64_tr_b16 v[74:75], v8 offset:26624
  ds_read_b64_tr_b16 v[76:77], v8 offset:28672
  ds_read_b64_tr_b16 v[78:79], v8 offset:30720
  ds_read_b64_tr_b16 v[80:81], v8 offset:32768
  ds_read_b64_tr_b16 v[82:83], v8 offset:34816
  s_waitcnt lgkmcnt(4)
  ds_read_b64_tr_b16 v[84:85], v8 offset:36864
  ds_read_b64_tr_b16 v[86:87], v8 offset:38912
  ds_read_b64_tr_b16 v[88:89], v8 offset:40960
  ds_read_b64_tr_b16 v[90:91], v8 offset:43008
  ds_read_b64_tr_b16 v[92:93], v8 offset:45056
  ds_read_b64_tr_b16 v[94:95], v8 offset:47104
  ds_read_b64_tr_b16 v[96:97], v8 offset:49152
  ds_read_b64_tr_b16 v[98:99], v8 offset:51200
  ds_read_b64_tr_b16 v[100:101], v8 offset:53248
  ds_read_b64_tr_b16 v[102:103], v8 offset:55296
  s_waitcnt lgkmcnt(4)
  ds_read_b64_tr_b16 v[104:105], v8 offset:57344
  ds_read_b64_tr_b16 v[106:107], v8 offset:59392
  ds_read_b64_tr_b16 v[108:109], v8 offset:61440
  ds_read_b64_tr_b16 v[110:111], v8 offset:63488
  ds_read_b64_tr_b16 v[112:113], v14 offset:0
  ds_read_b64_tr_b16 v[114:115], v14 offset:2048
  ds_read_b64_tr_b16 v[116:117], v14 offset:4096
  ds_read_b64_tr_b16 v[118:119], v14 offset:6144
  ds_read_b64_tr_b16 v[120:121], v14 offset:8192
  ds_read_b64_tr_b16 v[122:123], v14 offset:10240
  s_waitcnt lgkmcnt(4)
  ds_read_b64_tr_b16 v[124:125], v14 offset:12288
  ds_read_b64_tr_b16 v[126:127], v14 offset:14336
  ds_read_b64_tr_b16 v[128:129], v14 offset:16384
  ds_read_b64_tr_b16 v[130:131], v14 offset:18432
  ds_read_b64_tr_b16 v[132:133], v14 offset:20480
  ds_read_b64_tr_b16 v[134:135], v14 offset:22528
  ds_read_b64_tr_b16 v[136:137], v14 offset:24576
  ds_read_b64_tr_b16 v[138:139], v14 offset:26624
  ds_read_b64_tr_b16 v[140:141], v14 offset:28672
  ds_read_b64_tr_b16 v[142:143], v14 offset:30720
  s_waitcnt lgkmcnt(4)
  s_waitcnt lgkmcnt(0)
  s_mov_b64 exec, 1
  ds_add_u32 v4, v5 offset:16
  s_mov_b64 exec, -1
  s_branch L_ARRIVE
L_RNONE:
  s_mov_b64 exec, 1
  ds_add_u32 v4, v5 offset:16
  s_mov_b64 exec, -1
  s_waitcnt vmcnt(0) lgkmcnt(0)
  s_mov_b64 exec, 1
  ds_add_u32 v4, v5 offset:0
  s_mov_b64 exec, -1
  s_add_u32 s15, s15, 4
  s_mov_b32 s7, 1048576
LW_111:
  ds_read_b32 v6, v4 offset:0
  s_waitcnt lgkmcnt(0)
  v_cmp_le_u32 vcc, s15, v6
  s_cbranch_vccnz LWd_112
  s_sub_u32 s7, s7, 1
  s_cbranch_scc0 LW_111
  s_branch L_END
LWd_112:
  s_cmp_lg_u32 s3, 3
  s_cbranch_scc1 P3_113
  s_getreg_b32 s8, hwreg(HW_REG_XCC_ID, 0, 4)
  s_add_u32 s8, s8, s6
  v_mov_b32 v16, s8
  v_lshlrev_b32 v17, 2, v0
  s_lshl_b32 s8, s2, 6
  s_add_u32 s8, s8, 1179648
  s_mov_b64 exec, 0xffff
  buffer_store_dword v16, v17, s[52:55], s8 offen sc1
  s_mov_b64 exec, -1
P3_113:
L_ARRIVE:
  s_cmp_eq_u32 s3, 1
  s_cbranch_scc1 L_QGATHER
L_ARR1:
  s_mov_b64 exec, 1
  ds_add_u32 v4, v5 offset:20
  s_mov_b64 exec, -1
  s_cmp_eq_u32 s3, 0
  s_cbranch_scc1 L_GOW
  s_cmp_lg_u32 s3, 2
  s_cbranch_scc1 L_TAILROLE
  s_cmp_lg_u32 s98, 220
  s_cbranch_scc1 L_TAILROLE
  s_mov_b32 s7, 1048576
LW_114:
  ds_read_b32 v6, v4 offset:64
  s_waitcnt lgkmcnt(0)
  v_cmp_le_u32 vcc, 1, v6
  s_cbranch_vccnz LWd_115
  s_sleep 8
  s_sub_u32 s7, s7, 1
  s_cbranch_scc0 LW_114
  s_branch L_END
LWd_115:
  v_lshlrev_b32 v7, 6, v0
  s_mov_b32 s80, 1179648
  s_mov_b32 s81, 1183744
  s_mov_b32 s82, 1187840
  s_mov_b32 s83, 1191936
  s_mov_b32 s7, 1048576
GP_116:
  buffer_load_dword v20, v7, s[52:55], s80 offen sc1
  buffer_load_dword v21, v7, s[52:55], s81 offen sc1
  buffer_load_dword v22, v7, s[52:55], s82 offen sc1
  buffer_load_dword v23, v7, s[52:55], s83 offen sc1
  s_waitcnt vmcnt(0)
  v_subrev_u32 v20, s6, v20
  v_subrev_u32 v21, s6, v21
  v_subrev_u32 v22, s6, v22
  v_subrev_u32 v23, s6, v23
  v_max3_u32 v24, v20, v21, v22
  v_max_u32 v24, v24, v23
  v_cmp_le_u32 vcc, 16, v24
  s_cbranch_vccz GPok_117
  s_sleep 16
  s_sub_u32 s7, s7, 1
  s_cbranch_scc0 GP_116
  s_branch L_END
GPok_117:
  v_lshlrev_b32 v6, 2, v3
  ds_bpermute_b32 v24, v6, v20
  s_waitcnt lgkmcnt(0)
  v_bitop3_b32 v20, v20, v21, v24 bitop3:0x7e
  v_bitop3_b32 v22, v22, v23, v24 bitop3:0x7e
  v_or_b32 v20, v20, v22
  v_cmp_ne_u32 vcc, 0, v20
  s_nop 0
  s_cmp_eq_u64 vcc, 0
  s_cselect_b32 s8, 1, 0
  s_add_u32 s8, s8, s6
  v_mov_b32 v20, s8
  v_mov_b32 v21, s12
  v_lshlrev_b32 v6, 2, v0
  s_mov_b32 s8, 1212416
  s_mov_b64 exec, 0xffff
  buffer_store_dword v20, v6, s[52:55], s8 offen sc1
  buffer_store_dword v21, v6, s[52:55], 0 offen offset:0 sc1
  s_mov_b64 exec, -1
  s_branch L_TAILROLE
L_GOW:
  s_mov_b32 s7, 1048576
LW_118:
  ds_read_b32 v6, v4 offset:32
  s_waitcnt lgkmcnt(0)
  v_cmp_le_u32 vcc, 1, v6
  s_cbranch_vccnz LWd_119
  s_sleep 8
  s_sub_u32 s7, s7, 1
  s_cbranch_scc0 LW_118
  s_branch L_END
LWd_119:
  s_mov_b32 s8, 1212416
  s_mov_b32 s7, 1048576
GW_120:
  s_mov_b64 exec, 1
  buffer_load_dword v20, v4, s[52:55], s8 offen sc1
  s_mov_b64 exec, -1
  s_waitcnt vmcnt(0)
  v_readfirstlane_b32 s9, v20
  s_nop 0
  s_sub_u32 s9, s9, s6
  s_cmp_lt_u32 s9, 2
  s_cbranch_scc1 GWok_121
  s_sleep 32
  s_sub_u32 s7, s7, 1
  s_cbranch_scc0 GW_120
  s_branch L_END
GWok_121:
  s_lshl_b32 s9, s9, 8
  s_or_b32 s9, s9, s99
  s_or_b32 s9, s9, 0x10000
  v_mov_b32 v6, s9
  ds_write_b32 v4, v6 offset:24
  s_branch L_TAILROLE
L_QGATHER:
  v_lshlrev_b32 v7, 4, v0
  s_lshl_b32 s8, s5, 3
  s_add_u32 s8, s8, s4
  s_lshl_b32 s8, s8, 10
  s_add_u32 s8, s8, 917504
  s_mov_b32 s60, 2
  s_mov_b64 exec, 0
  s_branch W_G_0
L_RET_G2:
  s_mov_b32 s60, 0
  s_mov_b64 exec, -1
  s_mov_b32 s7, 1048576
LW_122:
  ds_read_b32 v6, v4 offset:28
  s_waitcnt lgkmcnt(0)
  v_cmp_le_u32 vcc, 1, v6
  s_cbranch_vccnz LWd_123
  s_sleep 4
  s_sub_u32 s7, s7, 1
  s_cbranch_scc0 LW_122
  s_branch L_END
LWd_123:
W_G_0:
  s_cbranch_execz W_G_1
  s_mov_b32 s7, 1048576
HP_124:
  s_buffer_load_dword s44, s[52:55], s8 offset:0xc0 glc
  s_buffer_load_dword s45, s[52:55], s8 offset:0x1c0 glc
  s_buffer_load_dword s46, s[52:55], s8 offset:0x2c0 glc
  s_buffer_load_dword s47, s[52:55], s8 offset:0x3c0 glc
  s_waitcnt lgkmcnt(0)
  s_xor_b32 s44, s44, s99
  s_xor_b32 s45, s45, s99
  s_xor_b32 s46, s46, s99
  s_xor_b32 s47, s47, s99
  s_or_b64 s[44:45], s[44:45], s[46:47]
  s_or_b32 s44, s44, s45
  s_and_b32 s44, s44, s101
  s_cbranch_scc0 HPok_125
  s_sleep 20
  s_sub_u32 s7, s7, 1
  s_cbranch_scc0 HP_124
  s_branch L_END
HPok_125:
  s_mov_b32 s7, 1048576
QG_126:
  buffer_load_dwordx4 v[24:27], v7, s[52:55], s8 offen sc1
  s_waitcnt vmcnt(0)
  v_xor_b32 v20, s99, v24
  v_xor_b32 v21, s1, v25
  v_xor_b32 v22, s99, v26
  v_xor_b32 v23, s1, v27
  v_or3_b32 v32, v20, v21, v22
  v_bitop3_b32 v32, v32, v23, s101 bitop3:0xa8
  v_cmp_ne_u32 vcc, 0, v32
  s_cbranch_vccz QGok_127
  s_sleep 2
  s_sub_u32 s7, s7, 1
  s_cbranch_scc0 QG_126
  s_branch L_END
QGok_127:
  v_permlane32_swap_b32 v20, v22
  v_permlane32_swap_b32 v21, v23
  v_pk_add_f32 v[20:21], v[20:21], v[22:23]
  v_cvt_pk_bf16_f32 v20, v20, v21
  v_and_b32 v6, 31, v0
  v_lshlrev_b32 v6, 3, v6
  v_lshrrev_b32 v7, 5, v0
  v_lshl_add_u32 v6, v7, 2, v6
  ds_write_b32 v6, v20 offset:256
W_G_1:
  s_cbranch_execz W_G_2
  s_mov_b64 exec, 1
  ds_add_u32 v4, v5 offset:4
  s_mov_b64 exec, -1
W_G_2:
  s_cbranch_execz L_WRET_G
  s_branch L_ARR1
L_TAILROLE:
  s_cmp_ge_u32 s98, 160
  s_cbranch_scc1 L_TAILHI
  s_mov_b32 s56, s24
  s_mov_b32 s57, s25
  s_mov_b32 s58, 5242880
  s_mov_b32 s59, 0x20000
  s_sub_u32 s93, s98, 140
  s_cmp_ge_u32 s98, 140
  s_cselect_b32 s92, 7, s96
  s_cselect_b32 s93, s93, s97
  s_cmp_ge_u32 s93, 10
  s_cselect_b32 s94, 1, 0
  s_mul_i32 s8, s94, 10
  s_sub_u32 s93, s93, s8
  s_lshl_b32 s8, s94, 4
  s_add_u32 s95, s92, s8
  s_lshr_b32 s8, s3, 1
  s_lshl_b32 s8, s8, 3
  s_add_u32 s95, s95, s8
  s_lshl_b32 s8, s94, 3
  s_add_u32 s92, s92, s8
  s_and_b32 s12, s3, 1
  s_lshr_b32 s9, s3, 1
  s_lshl_b32 s9, s9, 5
  v_and_b32 v50, 31, v0
  v_add_u32 v50, s9, v50
  s_lshl_b32 s8, s12, 2
  v_lshrrev_b32 v51, 5, v0
  v_add_u32 v51, s8, v51
  v_lshrrev_b32 v6, 4, v50
  v_lshlrev_b32 v53, 10, v6
  v_bfe_u32 v6, v50, 1, 2
  v_lshl_add_u32 v53, v6, 8, v53
  v_bfe_u32 v6, v50, 3, 1
  v_lshl_add_u32 v53, v6, 7, v53
  v_bfe_u32 v6, v50, 1, 3
  v_xor_b32 v6, v51, v6
  v_lshl_add_u32 v53, v6, 4, v53
  v_and_b32 v6, 1, v50
  v_lshl_add_u32 v53, v6, 3, v53
  v_xor_b32 v52, 32, v53
  s_mov_b32 s63, 0x07060302
  v_lshrrev_b32 v6, 3, v2
  v_lshl_add_u32 v7, v6, 2, v1
  v_xor_b32 v7, v7, v3
  v_lshlrev_b32 v55, 8, v1
  v_lshl_add_u32 v55, v6, 7, v55
  v_lshl_add_u32 v55, v7, 4, v55
  v_and_b32 v54, 1, v1
  v_lshlrev_b32 v54, 1, v54
  v_lshrrev_b32 v7, 1, v1
  v_add_u32 v54, v54, v7
  v_mul_u32_u24 v54, 81920, v54
  v_lshl_add_u32 v54, v2, 3, v54
  v_lshlrev_b32 v7, 4, v0
  s_lshl_b32 s11, s95, 12
  s_lshl_b32 s9, s12, 11
  s_add_u32 s11, s11, s9
  s_add_u32 s11, s11, 131072
  s_lshl_b32 s42, s93, 13
  s_lshl_b32 s9, s92, 8
  s_add_u32 s42, s42, s9
  s_lshr_b32 s9, s3, 1
  s_lshl_b32 s9, s9, 12
  s_add_u32 s42, s42, s9
  s_lshl_b32 s9, s12, 7
  s_add_u32 s42, s42, s9
  s_add_u32 s42, s42, 540672
  v_cmp_le_u32 s[44:45], 32, v0
  v_mov_b32 v61, s1
  s_mul_i32 s8, s95, 163840
  s_mul_i32 s9, s12, 81920
  s_add_u32 s8, s8, s9
  s_lshl_b32 s9, s93, 7
  s_add_u32 s8, s8, s9
  s_lshl_b32 s9, s3, 13
  s_add_u32 s9, s9, 16384
  s_cmp_lg_u32 s3, 3
  s_cbranch_scc1 WW_128
  s_mov_b32 s60, 1
  s_mov_b64 exec, 0
  s_branch W_W_0
L_RET_W1:
  s_mov_b32 s60, 0
  s_mov_b64 exec, -1
WW_128:
  s_mov_b32 s7, 1048576
LW_129:
  ds_read_b32 v6, v4 offset:20
  s_waitcnt lgkmcnt(0)
  v_cmp_le_u32 vcc, 4, v6
  s_cbranch_vccnz LWd_130
  s_sleep 4
  s_sub_u32 s7, s7, 1
  s_cbranch_scc0 LW_129
  s_branch L_END
LWd_130:
  s_mov_b32 s7, 1048576
LW_131:
  ds_read_b32 v6, v4 offset:40
  s_waitcnt lgkmcnt(0)
  v_cmp_le_u32 vcc, 1, v6
  s_cbranch_vccnz LWd_132
  s_sleep 4
  s_sub_u32 s7, s7, 1
  s_cbranch_scc0 LW_131
  s_branch L_END
LWd_132:
  v_mul_u32_u24 v12, 1280, v11
  v_add_u32 v12, v12, v10
  s_mov_b32 s80, s8
  s_add_u32 s81, s8, 19456
  s_add_u32 s82, s8, 3072
  s_add_u32 s83, s8, 22528
  s_mov_b32 m0, s9
  s_mov_b32 s14, 2
  s_mov_b32 s13, 40960
  buffer_load_dwordx4 v12, s[56:59], s80 offen offset:0 nt lds
  buffer_load_dwordx4 v12, s[56:59], s81 offen offset:1024 nt lds
  buffer_load_dwordx4 v12, s[56:59], s82 offen offset:2048 nt lds
  buffer_load_dwordx4 v12, s[56:59], s83 offen offset:3072 nt lds
  s_branch DMAn_134
DMA_133:
  s_waitcnt vmcnt(4)
  buffer_load_dwordx4 v12, s[56:59], s80 offen offset:0 nt lds
  s_waitcnt vmcnt(4)
  buffer_load_dwordx4 v12, s[56:59], s81 offen offset:1024 nt lds
  s_waitcnt vmcnt(4)
  buffer_load_dwordx4 v12, s[56:59], s82 offen offset:2048 nt lds
  s_waitcnt vmcnt(4)
  buffer_load_dwordx4 v12, s[56:59], s83 offen offset:3072 nt lds
DMAn_134:
  s_add_u32 m0, m0, 4096
  s_add_u32 s80, s80, s13
  s_add_u32 s81, s81, s13
  s_add_u32 s82, s82, s13
  s_add_u32 s83, s83, s13
  s_sub_u32 s14, s14, 1
  s_cmp_lg_u32 s14, 0
  s_cbranch_scc1 DMA_133
  s_waitcnt vmcnt(0) lgkmcnt(0)
  s_mov_b64 exec, 1
  ds_add_u32 v4, v5 offset:0
  s_mov_b64 exec, -1
  s_add_u32 s15, s15, 4
  s_mov_b32 s7, 1048576
LW_135:
  ds_read_b32 v6, v4 offset:0
  s_waitcnt lgkmcnt(0)
  v_cmp_le_u32 vcc, s15, v6
  s_cbranch_vccnz LWd_136
  s_sub_u32 s7, s7, 1
  s_cbranch_scc0 LW_135
  s_branch L_END
LWd_136:
  ds_read_b64_tr_b16 v[64:65], v8 offset:16384
  ds_read_b64_tr_b16 v[66:67], v8 offset:18432
  ds_read_b64_tr_b16 v[68:69], v8 offset:20480
  ds_read_b64_tr_b16 v[70:71], v8 offset:22528
  ds_read_b64_tr_b16 v[72:73], v8 offset:24576
  ds_read_b64_tr_b16 v[74:75], v8 offset:26624
  ds_read_b64_tr_b16 v[76:77], v8 offset:28672
  ds_read_b64_tr_b16 v[78:79], v8 offset:30720
  ds_read_b64_tr_b16 v[80:81], v8 offset:32768
  ds_read_b64_tr_b16 v[82:83], v8 offset:34816
  s_waitcnt lgkmcnt(4)
  ds_read_b64_tr_b16 v[84:85], v8 offset:36864
  ds_read_b64_tr_b16 v[86:87], v8 offset:38912
  ds_read_b64_tr_b16 v[88:89], v8 offset:40960
  ds_read_b64_tr_b16 v[90:91], v8 offset:43008
  ds_read_b64_tr_b16 v[92:93], v8 offset:45056
  ds_read_b64_tr_b16 v[94:95], v8 offset:47104
  s_waitcnt lgkmcnt(0)
W_W_0:
  s_cbranch_execz W_W_1
  s_mov_b32 s7, 1048576
LW_137:
  ds_read_b32 v6, v4 offset:60
  s_waitcnt lgkmcnt(0)
  v_cmp_le_u32 vcc, 1, v6
  s_cbranch_vccnz LWd_138
  s_sleep 2
  s_sub_u32 s7, s7, 1
  s_cbranch_scc0 LW_137
  s_branch L_END
LWd_138:
  s_mov_b64 s[46:47], -1
  s_mov_b64 s[48:49], -1
  s_mov_b32 s7, 1048576
  buffer_load_dwordx4 v[96:99], v7, s[52:55], s11 offen offset:0 sc1
  buffer_load_dwordx4 v[100:103], v7, s[52:55], s11 offen offset:1024 sc1
OBP_139:
  buffer_load_dwordx4 v[96:99], v7, s[52:55], s11 offen offset:0 sc1
OBk_141:
  buffer_load_dwordx4 v[100:103], v7, s[52:55], s11 offen offset:1024 sc1
OBk_142:
  s_waitcnt vmcnt(2)
  v_bitop3_b32 v104, v96, v98, s99 bitop3:0x7e
  v_bitop3_b32 v105, v97, v99, s1 bitop3:0x7e
  v_bitop3_b32 v106, v100, v102, s99 bitop3:0x7e
  v_bitop3_b32 v107, v101, v103, s1 bitop3:0x7e
  v_bitop3_b32 v104, v104, v105, s101 bitop3:0xa8
  v_bitop3_b32 v106, v106, v107, s101 bitop3:0xa8
  v_cmp_ne_u32 s[46:47], 0, v104
  v_cmp_ne_u32 s[48:49], 0, v106
  v_perm_b32 v108, v97, v96, s63
  v_perm_b32 v109, v99, v98, s63
  v_perm_b32 v110, v101, v100, s63
  v_perm_b32 v111, v103, v102, s63
  s_or_b64 s[8:9], s[46:47], s[48:49]
  s_cbranch_scc0 OBok_140
  s_sub_u32 s7, s7, 1
  s_cbranch_scc0 OBP_139
  s_branch L_END
OBok_140:
  ds_write_b64 v53, v[108:109] offset:5120
W_W_1:
  s_cbranch_execz W_W_2
  ds_write_b64 v52, v[110:111] offset:5120
  s_waitcnt lgkmcnt(0)
  s_barrier
  ds_read_b128 v[136:139], v55 offset:5120
  ds_read_b128 v[140:143], v55 offset:6144
  ds_read_b128 v[144:147], v55 offset:7168
  ds_read_b128 v[148:151], v55 offset:8192
  s_waitcnt lgkmcnt(3)
  v_mfma_f32_16x16x32_bf16 v[124:127], v[136:139], v[64:67], 0
  v_mfma_f32_16x16x32_bf16 v[128:131], v[136:139], v[68:71], 0
  s_waitcnt lgkmcnt(2)
  v_mfma_f32_16x16x32_bf16 v[124:127], v[140:143], v[72:75], v[124:127]
  v_mfma_f32_16x16x32_bf16 v[128:131], v[140:143], v[76:79], v[128:131]
  s_waitcnt lgkmcnt(1)
  v_mfma_f32_16x16x32_bf16 v[124:127], v[144:147], v[80:83], v[124:127]
  v_mfma_f32_16x16x32_bf16 v[128:131], v[144:147], v[84:87], v[128:131]
  s_waitcnt lgkmcnt(0)
  v_mfma_f32_16x16x32_bf16 v[124:127], v[148:151], v[88:91], v[124:127]
  v_mfma_f32_16x16x32_bf16 v[128:131], v[148:151], v[92:95], v[128:131]
  s_nop 7
  v_cndmask_b32 v132, v124, v130, s[44:45]
  v_cndmask_b32 v133, v125, v131, s[44:45]
  v_permlane32_swap_b32 v128, v126
  v_permlane32_swap_b32 v129, v127
  v_cndmask_b32 v134, v126, v128, s[44:45]
  v_cndmask_b32 v135, v127, v129, s[44:45]
  v_pk_add_f32 v[132:133], v[132:133], v[134:135]
  v_bfi_b32 v132, s101, v15, v132
  v_bfi_b32 v133, s101, v61, v133
  buffer_store_dwordx2 v[132:133], v54, s[52:55], s42 offen sc1
W_W_2:
  s_cbranch_execz L_WRET_W
  s_branch L_END
L_TAILHI:
  s_cmp_lg_u32 s3, 2
  s_cbranch_scc1 HW_143
HW_143:
  s_cmp_lg_u32 s96, 7
  s_cbranch_scc1 L_END
  s_cmp_lg_u32 s3, 3
  s_cbranch_scc1 HW_144
  s_mov_b32 s60, 1
  s_mov_b64 exec, 0
  s_branch W_X1_0
L_RET_X11:
  s_mov_b32 s60, 0
  s_mov_b64 exec, -1
  s_mov_b32 s60, 1
  s_mov_b64 exec, 0
  s_branch W_X2_0
L_RET_X21:
  s_mov_b32 s60, 0
  s_mov_b64 exec, -1
HW_144:
  s_mov_b32 s56, s30
  s_mov_b32 s57, s31
  s_mov_b32 s58, 2211840
  s_mov_b32 s59, 0x20000
  s_mov_b32 s7, 1048576
LW_145:
  ds_read_b32 v6, v4 offset:24
  s_waitcnt lgkmcnt(0)
  v_cmp_le_u32 vcc, 1, v6
  s_cbranch_vccnz LWd_146
  s_sleep 8
  s_sub_u32 s7, s7, 1
  s_cbranch_scc0 LW_145
  s_branch L_END
LWd_146:
  v_readfirstlane_b32 s99, v6
  s_movk_i32 s101, 0xff
  s_bfe_u32 s100, s99, 0x10008
  s_and_b32 s99, s99, s101
  s_or_b32 s61, s99, 0x3f00
  s_lshl_b32 s61, s61, 16
  s_xor_b32 s1, s99, 0x55
  s_xor_b32 s0, s61, 0x550000
  v_mov_b32 v16, 0xffbfffbf
  v_mov_b32 v17, 0xffbfffbf
  v_mov_b32 v18, 0xffbfffbf
  v_mov_b32 v19, 0xffbfffbf
  v_lshlrev_b32 v7, 4, v0
  s_lshl_b32 s8, s3, 5
  s_add_u32 s8, s8, s97
  s_mul_i32 s8, s8, 1728
  s_add_u32 s8, s8, 262144
L_CLR:
  buffer_load_dwordx4 v[20:23], v7, s[52:55], s8 offen offset:0 sc1
  buffer_load_dwordx4 v[24:27], v7, s[52:55], s8 offen offset:1024 sc1
  s_waitcnt vmcnt(0)
  s_cmp_eq_u32 s100, 0
  s_cbranch_scc1 MS_147
  buffer_store_dwordx4 v[16:19], v7, s[52:55], s8 offen
MSd_148:
  s_mov_b32 exec_hi, 0xfff
  s_cmp_eq_u32 s100, 0
  s_cbranch_scc1 MS_149
  buffer_store_dwordx4 v[16:19], v7, s[52:55], s8 offen offset:1024
MSd_150:
  s_mov_b64 exec, -1
  s_add_u32 s8, s8, 221184
  s_cmp_lt_u32 s8, 538624
  s_cbranch_scc1 L_CLR
  s_waitcnt vmcnt(0)
  s_mov_b64 exec, 1
  ds_add_u32 v4, v5 offset:72
  s_mov_b64 exec, -1
  v_mul_u32_u24 v245, 1280, v11
  v_add_u32 v245, v245, v10
  s_mov_b32 s68, s36
  s_mov_b32 s69, s37
  s_mov_b32 s70, 10240
  s_mov_b32 s71, 0x20000
  v_lshlrev_b32 v248, 3, v0
  v_lshlrev_b32 v247, 4, v0
  v_mul_u32_u24 v250, 1280, v3
  v_lshrrev_b32 v6, 1, v1
  v_lshl_add_u32 v251, v6, 2, v250
  v_lshl_add_u32 v250, v1, 1, v250
  v_and_b32 v252, 1, v1
  v_lshlrev_b32 v252, 4, v252
  v_sub_u32 v252, 16, v252
  s_lshl_b32 s8, s3, 5
  s_add_u32 s8, s8, s97
  s_lshl_b32 s42, s8, 3
  s_add_u32 s43, s42, 98304
  s_mul_i32 s6, s8, 1728
  s_add_u32 s6, s6, 262144
  s_cmp_ge_u32 s3, 5
  s_cbranch_scc1 NT4_151
  s_add_u32 s9, s42, 79872
  buffer_load_dword v249, v251, s[52:55], s9 offen sc1
  buffer_load_dwordx4 v[212:215], v247, s[52:55], s6 offen offset:0 sc1
  buffer_load_dwordx4 v[216:219], v247, s[52:55], s6 offen offset:1024 sc1
NT4_151:
  v_lshlrev_b32 v7, 3, v0
  s_mul_i32 s8, s3, 1280
  s_add_u32 s11, s8, 98304
  s_add_u32 s8, s8, 59392
  s_add_u32 s9, s8, 10240
  buffer_load_dwordx2 v[40:41], v7, s[52:55], s8 offen offset:0 sc1
  buffer_load_dwordx2 v[42:43], v7, s[52:55], s8 offen offset:512 sc1
  s_mov_b32 exec_hi, 0
  buffer_load_dwordx2 v[44:45], v7, s[52:55], s8 offen offset:1024 sc1
  s_mov_b64 exec, -1
  buffer_load_dwordx2 v[46:47], v7, s[52:55], s9 offen offset:0 sc1
  buffer_load_dwordx2 v[48:49], v7, s[52:55], s9 offen offset:512 sc1
  s_mov_b32 exec_hi, 0
  buffer_load_dwordx2 v[50:51], v7, s[52:55], s9 offen offset:1024 sc1
  s_mov_b64 exec, -1
  buffer_load_dwordx4 v[232:235], v247, s[52:55], s11 offen sc1
  buffer_load_dword v236, v7, s[52:55], s11 offen offset:1024 sc1
  s_and_b32 s10, s3, 3
  s_lshl_b32 s8, s10, 2
  v_add_u32 v58, s8, v1
  v_lshrrev_b32 v6, 4, v58
  v_lshlrev_b32 v62, 10, v6
  v_bfe_u32 v6, v58, 1, 2
  v_lshl_add_u32 v62, v6, 8, v62
  v_bfe_u32 v6, v58, 3, 1
  v_lshl_add_u32 v62, v6, 7, v62
  v_bfe_u32 v6, v58, 1, 3
  v_xor_b32 v6, v3, v6
  v_lshl_add_u32 v62, v6, 4, v62
  v_and_b32 v6, 1, v58
  v_lshl_add_u32 v62, v6, 3, v62
  v_lshrrev_b32 v6, 3, v2
  v_lshl_add_u32 v62, v6, 2, v62
  v_mul_u32_u24 v63, 1728, v1
  v_lshl_add_u32 v63, v3, 3, v63
  v_lshrrev_b32 v6, 3, v2
  v_mul_u32_u24 v6, 27648, v6
  v_add_u32 v63, v63, v6
  s_cmp_lt_u32 s3, 4
  s_cselect_b32 s8, 165888, 0
  s_mul_i32 s9, s10, 6912
  s_add_u32 s8, s8, s9
  s_lshl_b32 s9, s97, 6
  s_add_u32 s8, s8, s9
  s_add_u32 s8, s8, 262144
  v_add_u32 v63, s8, v63
  v_lshrrev_b32 v6, 4, v0
  v_lshlrev_b32 v13, 10, v6
  v_bfe_u32 v6, v0, 1, 2
  v_lshl_add_u32 v13, v6, 8, v13
  v_bfe_u32 v6, v0, 3, 1
  v_lshl_add_u32 v13, v6, 7, v13
  v_bfe_u32 v6, v0, 1, 3
  v_xor_b32 v6, s3, v6
  v_lshl_add_u32 v13, v6, 4, v13
  v_and_b32 v6, 1, v0
  v_lshl_add_u32 v13, v6, 3, v13
  v_mov_b32 v58, v7
  v_lshrrev_b32 v6, 3, v2
  v_lshl_add_u32 v7, v6, 2, v1
  v_xor_b32 v7, v7, v3
  v_lshlrev_b32 v12, 8, v1
  v_lshl_add_u32 v12, v6, 7, v12
  v_lshl_add_u32 v12, v7, 4, v12
  v_xor_b32 v10, 0xc0, v12
  v_mov_b32 v7, v58
  v_mov_b32 v15, s99
  s_waitcnt vmcnt(0)
  v_lshlrev_b32 v249, v252, v249
  v_and_b32 v249, 0xffff0000, v249
  v_lshlrev_b32 v28, 16, v40
  v_and_b32 v29, 0xffff0000, v40
  v_lshlrev_b32 v16, 16, v46
  v_and_b32 v17, 0xffff0000, v46
  v_lshlrev_b32 v30, 16, v41
  v_and_b32 v31, 0xffff0000, v41
  v_lshlrev_b32 v18, 16, v47
  v_and_b32 v19, 0xffff0000, v47
  v_lshlrev_b32 v32, 16, v42
  v_and_b32 v33, 0xffff0000, v42
  v_lshlrev_b32 v20, 16, v48
  v_and_b32 v21, 0xffff0000, v48
  v_lshlrev_b32 v34, 16, v43
  v_and_b32 v35, 0xffff0000, v43
  v_lshlrev_b32 v22, 16, v49
  v_and_b32 v23, 0xffff0000, v49
  v_lshlrev_b32 v36, 16, v44
  v_and_b32 v37, 0xffff0000, v44
  v_lshlrev_b32 v24, 16, v50
  v_and_b32 v25, 0xffff0000, v50
  v_lshlrev_b32 v38, 16, v45
  v_and_b32 v39, 0xffff0000, v45
  v_lshlrev_b32 v26, 16, v51
  v_and_b32 v27, 0xffff0000, v51
  v_add_f32 v16, 1.0, v16
  v_add_f32 v17, 1.0, v17
  v_add_f32 v18, 1.0, v18
  v_add_f32 v19, 1.0, v19
  v_add_f32 v20, 1.0, v20
  v_add_f32 v21, 1.0, v21
  v_add_f32 v22, 1.0, v22
  v_add_f32 v23, 1.0, v23
  v_add_f32 v24, 1.0, v24
  v_add_f32 v25, 1.0, v25
  v_add_f32 v26, 1.0, v26
  v_add_f32 v27, 1.0, v27
  v_mov_b32 v44, 0
  v_mov_b32 v45, 0
  v_mov_b32 v54, 0
  v_mov_b32 v55, 0
  v_mov_b32 v56, 0
  v_mov_b32 v57, 0
  v_mov_b32 v2, 0x3f80
  v_mov_b32 v3, 1.0
  s_cmp_ge_u32 s97, 27
  s_cbranch_scc1 L_X7S
  s_and_b32 s10, s3, 1
  s_lshr_b32 s12, s3, 1
  s_mul_i32 s8, s97, 81920
  s_mul_i32 s9, s10, 40960
  s_add_u32 s8, s8, s9
  s_lshl_b32 s9, s12, 7
  s_add_u32 s8, s8, s9
  s_lshl_b32 s9, s12, 13
  s_lshl_b32 s10, s10, 12
  s_add_u32 s9, s9, s10
  s_add_u32 s9, s9, 16384
  s_mov_b32 s7, 1048576
LW_152:
  ds_read_b32 v6, v4 offset:36
  s_waitcnt lgkmcnt(0)
  v_cmp_le_u32 vcc, 4, v6
  s_cbranch_vccnz LWd_153
  s_sleep 2
  s_sub_u32 s7, s7, 1
  s_cbranch_scc0 LW_152
  s_branch L_END
LWd_153:
  s_mov_b32 s80, s8
  s_add_u32 s81, s8, 19456
  s_add_u32 s82, s8, 3072
  s_add_u32 s83, s8, 22528
  s_mov_b32 m0, s9
  s_mov_b32 s14, 5
  s_mov_b32 s13, 256
  buffer_load_dwordx4 v245, s[56:59], s80 offen offset:0 nt lds
  buffer_load_dwordx4 v245, s[56:59], s81 offen offset:1024 nt lds
  buffer_load_dwordx4 v245, s[56:59], s82 offen offset:2048 nt lds
  buffer_load_dwordx4 v245, s[56:59], s83 offen offset:3072 nt lds
  s_branch DMAn_155
DMA_154:
  s_waitcnt vmcnt(4)
  buffer_load_dwordx4 v245, s[56:59], s80 offen offset:0 nt lds
  s_waitcnt vmcnt(4)
  buffer_load_dwordx4 v245, s[56:59], s81 offen offset:1024 nt lds
  s_waitcnt vmcnt(4)
  buffer_load_dwordx4 v245, s[56:59], s82 offen offset:2048 nt lds
  s_waitcnt vmcnt(4)
  buffer_load_dwordx4 v245, s[56:59], s83 offen offset:3072 nt lds
DMAn_155:
  s_add_u32 m0, m0, 16384
  s_add_u32 s80, s80, s13
  s_add_u32 s81, s81, s13
  s_add_u32 s82, s82, s13
  s_add_u32 s83, s83, s13
  s_sub_u32 s14, s14, 1
  s_cmp_lg_u32 s14, 0
  s_cbranch_scc1 DMA_154
L_X7S:
W_X2_0:
  s_cbranch_execz W_X2_1
  s_mov_b32 s7, 1048576
LW_156:
  ds_read_b32 v6, v4 offset:60
  s_waitcnt lgkmcnt(0)
  v_cmp_le_u32 vcc, 1, v6
  s_cbranch_vccnz LWd_157
  s_sleep 2
  s_sub_u32 s7, s7, 1
  s_cbranch_scc0 LW_156
  s_branch L_END
LWd_157:
  buffer_load_dwordx4 v[232:235], v247, s[52:55], s6 offen offset:0 sc1
  buffer_load_dwordx4 v[236:239], v247, s[52:55], s6 offen offset:1024 sc1
  s_cmp_ge_u32 s97, 27
  s_cbranch_scc1 L_T4
  s_waitcnt vmcnt(0) lgkmcnt(0)
  s_mov_b64 exec, 1
  ds_add_u32 v4, v5 offset:0
  s_mov_b64 exec, -1
  s_add_u32 s15, s15, 4
  s_mov_b32 s7, 1048576
LW_158:
  ds_read_b32 v6, v4 offset:0
  s_waitcnt lgkmcnt(0)
  v_cmp_le_u32 vcc, s15, v6
  s_cbranch_vccnz LWd_159
  s_sub_u32 s7, s7, 1
  s_cbranch_scc0 LW_158
  s_branch L_END
LWd_159:
  ds_read_b64_tr_b16 v[144:145], v14 offset:0
  ds_read_b64_tr_b16 v[146:147], v14 offset:2048
  ds_read_b64_tr_b16 v[148:149], v14 offset:4096
  ds_read_b64_tr_b16 v[150:151], v14 offset:6144
  ds_read_b64_tr_b16 v[152:153], v14 offset:8192
  ds_read_b64_tr_b16 v[154:155], v14 offset:10240
  ds_read_b64_tr_b16 v[156:157], v14 offset:12288
  ds_read_b64_tr_b16 v[158:159], v14 offset:14336
  ds_read_b64_tr_b16 v[160:161], v14 offset:16384
  ds_read_b64_tr_b16 v[162:163], v14 offset:18432
  s_waitcnt lgkmcnt(4)
  ds_read_b64_tr_b16 v[164:165], v14 offset:20480
W_X2_1:
  s_cbranch_execz W_X2_2
  ds_read_b64_tr_b16 v[166:167], v14 offset:22528
  ds_read_b64_tr_b16 v[168:169], v14 offset:24576
  ds_read_b64_tr_b16 v[170:171], v14 offset:26624
  ds_read_b64_tr_b16 v[172:173], v14 offset:28672
  ds_read_b64_tr_b16 v[174:175], v14 offset:30720
  s_waitcnt lgkmcnt(0)
L_LN:
  s_setprio 2
  s_mov_b32 s80, 55296
  s_mov_b32 s81, 110592
  s_mov_b32 s82, 0xff00ff00
  s_mov_b32 s83, 0xff00ff00
  s_mov_b32 s7, 1048576
  s_mov_b32 s10, 0xffbfffbf
  s_mov_b64 s[92:93], -1
  s_mov_b64 s[94:95], -1
  s_mov_b32 s78, -1
  s_mov_b32 s79, 0
LNP_160:
  s_mov_b64 exec, s[92:93]
  s_cbranch_execz LNk_162
  buffer_load_dwordx2 v[40:41], v248, s[52:55], s11 offen offset:0 sc1
LNk_162:
  s_mov_b64 exec, s[94:95]
  s_cbranch_execz LNk_163
  buffer_load_dwordx2 v[42:43], v248, s[52:55], s11 offen offset:512 sc1
LNk_163:
  s_mov_b64 exec, s[78:79]
  s_cbranch_execz LNk_164
  buffer_load_dwordx2 v[44:45], v248, s[52:55], s11 offen offset:1024 sc1
LNk_164:
  s_mov_b64 exec, -1
  s_waitcnt vmcnt(0)
  v_max3_u32 v58, v40, v41, v42
  v_readfirstlane_b32 s8, v40
  v_max3_u32 v59, v43, v44, v45
  v_max_u32 v58, v58, v59
  v_cmp_le_u32 vcc, s10, v58
  s_cbranch_vccz LNok_161
  s_mov_b64 s[12:13], 0
  v_cmp_eq_u32 s[92:93], s10, v40
  v_cmp_eq_u32 vcc, s10, v41
  s_nop 0
  s_or_b64 s[92:93], s[92:93], vcc
W_X2_2:
  s_cbranch_execz W_X2_3
  s_or_b64 s[12:13], s[12:13], s[92:93]
  v_cmp_eq_u32 s[94:95], s10, v42
  v_cmp_eq_u32 vcc, s10, v43
  s_nop 0
  s_or_b64 s[94:95], s[94:95], vcc
  s_or_b64 s[12:13], s[12:13], s[94:95]
  v_cmp_eq_u32 s[78:79], s10, v44
  v_cmp_eq_u32 vcc, s10, v45
  s_nop 0
  s_or_b64 s[78:79], s[78:79], vcc
  s_or_b64 s[12:13], s[12:13], s[78:79]
  s_cmp_eq_u64 s[12:13], 0
  s_cbranch_scc1 LNok_161
  s_sub_u32 s7, s7, 1
  s_cbranch_scc0 LNP_160
  s_branch L_END
LNok_161:
  s_lshl_b32 s8, s8, 16
  s_xor_b32 s8, s8, 0x80000000
  v_dot2_f32_bf16 v46, v40, v2, s8
  v_dot2_f32_bf16 v47, v40, v3, s8
  v_dot2_f32_bf16 v48, v41, v2, s8
  v_dot2_f32_bf16 v49, v41, v3, s8
  v_dot2_f32_bf16 v50, v42, v2, s8
  v_dot2_f32_bf16 v51, v42, v3, s8
  v_dot2_f32_bf16 v52, v43, v2, s8
  v_dot2_f32_bf16 v53, v43, v3, s8
  s_mov_b32 exec_hi, 0
  v_dot2_f32_bf16 v54, v44, v2, s8
  v_dot2_f32_bf16 v55, v44, v3, s8
  v_dot2_f32_bf16 v56, v45, v2, s8
  v_dot2_f32_bf16 v57, v45, v3, s8
  s_mov_b64 exec, -1
  v_pk_add_f32 v[58:59], v[46:47], v[48:49]
  v_pk_mul_f32 v[60:61], v[46:47], v[46:47]
  v_pk_fma_f32 v[60:61], v[48:49], v[48:49], v[60:61]
  v_pk_add_f32 v[58:59], v[58:59], v[50:51]
W_X2_3:
  s_cbranch_execz W_X2_4
  v_pk_fma_f32 v[60:61], v[50:51], v[50:51], v[60:61]
  v_pk_add_f32 v[58:59], v[58:59], v[52:53]
  v_pk_fma_f32 v[60:61], v[52:53], v[52:53], v[60:61]
  v_pk_add_f32 v[58:59], v[58:59], v[54:55]
  v_pk_fma_f32 v[60:61], v[54:55], v[54:55], v[60:61]
  v_pk_add_f32 v[58:59], v[58:59], v[56:57]
  v_pk_fma_f32 v[60:61], v[56:57], v[56:57], v[60:61]
  v_add_f32 v58, v58, v59
  v_add_f32 v59, v60, v61
  v_pk_mul_f32 v[56:57], v[56:57], v[26:27]
  v_pk_mul_f32 v[54:55], v[54:55], v[24:25]
  v_permlane16_swap_b32 v58, v59
  v_add_f32 v58, v58, v59
  v_pk_mul_f32 v[52:53], v[52:53], v[22:23]
  s_nop 0
  v_add_f32_dpp v58, v58, v58 row_ror:1 row_mask:0xf bank_mask:0xf
  v_pk_mul_f32 v[50:51], v[50:51], v[20:21]
  s_nop 0
  v_add_f32_dpp v58, v58, v58 row_ror:2 row_mask:0xf bank_mask:0xf
  v_pk_mul_f32 v[48:49], v[48:49], v[18:19]
  s_nop 0
  v_add_f32_dpp v58, v58, v58 row_ror:4 row_mask:0xf bank_mask:0xf
  v_pk_mul_f32 v[46:47], v[46:47], v[16:17]
  s_nop 0
  v_add_f32_dpp v58, v58, v58 row_ror:8 row_mask:0xf bank_mask:0xf
  s_nop 0
  v_readlane_b32 s76, v58, 0
  v_readlane_b32 s77, v58, 16
  v_readlane_b32 s78, v58, 32
  v_readlane_b32 s79, v58, 48
  v_mov_b32 v60, s76
  v_mov_b32 v61, s77
  v_add_f32 v60, s78, v60
  v_add_f32 v61, s79, v61
W_X2_4:
  s_cbranch_execz W_X2_5
  v_mul_f32 v60, 0xbacccccd, v60
  v_mul_f32 v61, 0x3acccccd, v61
  v_fma_f32 v61, -v60, v60, v61
  v_max_f32 v61, 0, v61
  v_add_f32 v61, 0x3727c5ac, v61
  v_rsq_f32 v61, v61
  s_nop 0
  v_pk_fma_f32 v[46:47], v[16:17], v[60:61], v[46:47] op_sel_hi:[1,0,1]
  v_pk_fma_f32 v[48:49], v[18:19], v[60:61], v[48:49] op_sel_hi:[1,0,1]
  v_pk_fma_f32 v[50:51], v[20:21], v[60:61], v[50:51] op_sel_hi:[1,0,1]
  v_pk_fma_f32 v[52:53], v[22:23], v[60:61], v[52:53] op_sel_hi:[1,0,1]
  v_pk_fma_f32 v[54:55], v[24:25], v[60:61], v[54:55] op_sel_hi:[1,0,1]
  v_pk_fma_f32 v[56:57], v[26:27], v[60:61], v[56:57] op_sel_hi:[1,0,1]
  v_pk_fma_f32 v[46:47], v[46:47], v[60:61], v[28:29] op_sel:[0,1,0] op_sel_hi:[1,1,1]
  v_pk_fma_f32 v[48:49], v[48:49], v[60:61], v[30:31] op_sel:[0,1,0] op_sel_hi:[1,1,1]
  v_pk_fma_f32 v[50:51], v[50:51], v[60:61], v[32:33] op_sel:[0,1,0] op_sel_hi:[1,1,1]
  v_pk_fma_f32 v[52:53], v[52:53], v[60:61], v[34:35] op_sel:[0,1,0] op_sel_hi:[1,1,1]
  v_pk_fma_f32 v[54:55], v[54:55], v[60:61], v[36:37] op_sel:[0,1,0] op_sel_hi:[1,1,1]
  v_pk_fma_f32 v[56:57], v[56:57], v[60:61], v[38:39] op_sel:[0,1,0] op_sel_hi:[1,1,1]
  s_waitcnt vmcnt(0)
  v_cvt_pk_bf16_f32 v40, v46, v47
  v_cvt_pk_bf16_f32 v41, v48, v49
  v_cvt_pk_bf16_f32 v42, v50, v51
  v_cvt_pk_bf16_f32 v43, v52, v53
  v_cvt_pk_bf16_f32 v44, v54, v55
  v_cvt_pk_bf16_f32 v45, v56, v57
  ds_write_b64 v13, v[40:41] offset:5120
  ds_write_b64 v13, v[42:43] offset:9216
  s_mov_b32 exec_hi, 0
  ds_write_b64 v13, v[44:45] offset:13312
W_X2_5:
  s_cbranch_execz W_X2_6
  s_mov_b64 exec, -1
  s_waitcnt lgkmcnt(0)
  s_barrier
  buffer_load_dword v240, v251, s[52:55], s43 offen sc1
  s_cmp_ge_u32 s3, 4
  s_cbranch_scc1 L_YB
  ds_read_b128 v[192:195], v12 offset:5120
  ds_read_b128 v[196:199], v12 offset:6144
  ds_read_b128 v[200:203], v12 offset:7168
  ds_read_b128 v[204:207], v12 offset:8192
  ds_read_b128 v[208:211], v12 offset:9216
  ds_read_b128 v[212:215], v12 offset:10240
  ds_read_b128 v[216:219], v12 offset:11264
  ds_read_b128 v[220:223], v12 offset:12288
  ds_read_b128 v[224:227], v12 offset:13312
  ds_read_b128 v[228:231], v12 offset:14336
  s_waitcnt lgkmcnt(9)
  v_mfma_f32_16x16x32_bf16 v[40:43], v[64:67], v[192:195], 0
  v_mfma_f32_16x16x32_bf16 v[44:47], v[68:71], v[192:195], 0
  s_waitcnt lgkmcnt(8)
  v_mfma_f32_16x16x32_bf16 v[40:43], v[72:75], v[196:199], v[40:43]
  v_mfma_f32_16x16x32_bf16 v[44:47], v[76:79], v[196:199], v[44:47]
  s_waitcnt lgkmcnt(7)
  v_mfma_f32_16x16x32_bf16 v[40:43], v[80:83], v[200:203], v[40:43]
  v_mfma_f32_16x16x32_bf16 v[44:47], v[84:87], v[200:203], v[44:47]
  s_waitcnt lgkmcnt(6)
  v_mfma_f32_16x16x32_bf16 v[40:43], v[88:91], v[204:207], v[40:43]
  v_mfma_f32_16x16x32_bf16 v[44:47], v[92:95], v[204:207], v[44:47]
  s_waitcnt lgkmcnt(5)
  v_mfma_f32_16x16x32_bf16 v[40:43], v[96:99], v[208:211], v[40:43]
  v_mfma_f32_16x16x32_bf16 v[44:47], v[100:103], v[208:211], v[44:47]
  s_waitcnt lgkmcnt(4)
  v_mfma_f32_16x16x32_bf16 v[40:43], v[104:107], v[212:215], v[40:43]
W_X2_6:
  s_cbranch_execz W_X2_7
  v_mfma_f32_16x16x32_bf16 v[44:47], v[108:111], v[212:215], v[44:47]
  s_waitcnt lgkmcnt(3)
  v_mfma_f32_16x16x32_bf16 v[40:43], v[112:115], v[216:219], v[40:43]
  v_mfma_f32_16x16x32_bf16 v[44:47], v[116:119], v[216:219], v[44:47]
  s_waitcnt lgkmcnt(2)
  v_mfma_f32_16x16x32_bf16 v[40:43], v[120:123], v[220:223], v[40:43]
  v_mfma_f32_16x16x32_bf16 v[44:47], v[124:127], v[220:223], v[44:47]
  s_waitcnt lgkmcnt(1)
  v_mfma_f32_16x16x32_bf16 v[40:43], v[128:131], v[224:227], v[40:43]
  v_mfma_f32_16x16x32_bf16 v[44:47], v[132:135], v[224:227], v[44:47]
  s_waitcnt lgkmcnt(0)
  v_mfma_f32_16x16x32_bf16 v[40:43], v[136:139], v[228:231], v[40:43]
  v_mfma_f32_16x16x32_bf16 v[44:47], v[140:143], v[228:231], v[44:47]
  s_nop 7
  v_add_f32_dpp v48, v44, v40 row_ror:8 row_mask:0xf bank_mask:0x3
  v_add_f32_dpp v49, v45, v41 row_ror:8 row_mask:0xf bank_mask:0x3
  v_add_f32_dpp v48, v42, v46 row_ror:8 row_mask:0xf bank_mask:0xc
  v_add_f32_dpp v49, v43, v47 row_ror:8 row_mask:0xf bank_mask:0xc
  v_mul_f32 v50, 0xbfb8aa3b, v48
  v_mul_f32 v51, 0xbfb8aa3b, v49
  v_exp_f32 v50, v50
  v_exp_f32 v51, v51
  v_add_f32 v50, 1.0, v50
  v_add_f32 v51, 1.0, v51
  v_rcp_f32 v50, v50
  v_rcp_f32 v51, v51
  v_mul_f32 v48, v48, v50
  v_mul_f32 v49, v49, v51
  v_cvt_pk_bf16_f32 v48, v48, v49
  ds_write_b32 v62, v48 offset:2560
L_YB:
  s_waitcnt lgkmcnt(0)
  s_barrier
  ds_read_b128 v[192:195], v12 offset:2560
  ds_read_b128 v[196:199], v10 offset:2560
  s_waitcnt lgkmcnt(1)
  v_mfma_f32_16x16x32_bf16 v[16:19], v[144:147], v[192:195], 0
W_X2_7:
  s_cbranch_execz W_X2_8
  v_mfma_f32_16x16x32_bf16 v[20:23], v[156:159], v[192:195], 0
  s_waitcnt lgkmcnt(0)
  v_mfma_f32_16x16x32_bf16 v[16:19], v[148:151], v[196:199], v[16:19]
  v_mfma_f32_16x16x32_bf16 v[20:23], v[152:155], v[196:199], v[20:23]
  v_mfma_f32_16x16x32_bf16 v[24:27], v[160:163], v[192:195], 0
  v_mfma_f32_16x16x32_bf16 v[28:31], v[172:175], v[192:195], 0
  v_mfma_f32_16x16x32_bf16 v[24:27], v[164:167], v[196:199], v[24:27]
  v_mfma_f32_16x16x32_bf16 v[28:31], v[168:171], v[196:199], v[28:31]
  s_cmp_lt_u32 s3, 4
  s_cbranch_scc1 L_Y2
  s_nop 0
  v_cvt_pk_bf16_f32 v40, v16, v17
  v_cvt_pk_bf16_f32 v41, v18, v19
  s_mov_b64 exec, s[82:83]
  v_cvt_pk_bf16_f32 v40, v20, v21
  v_cvt_pk_bf16_f32 v41, v22, v23
  s_mov_b64 exec, -1
  s_cmp_eq_u32 s100, 0
  s_cbranch_scc1 MS_165
  buffer_store_dwordx2 v[40:41], v63, s[52:55], 0 offen
MSd_166:
  v_mfma_f32_16x16x32_bf16 v[32:35], v[176:179], v[192:195], 0
  v_mfma_f32_16x16x32_bf16 v[36:39], v[188:191], v[192:195], 0
  v_mfma_f32_16x16x32_bf16 v[32:35], v[180:183], v[196:199], v[32:35]
  v_mfma_f32_16x16x32_bf16 v[36:39], v[184:187], v[196:199], v[36:39]
  v_cvt_pk_bf16_f32 v42, v24, v25
  v_cvt_pk_bf16_f32 v43, v26, v27
  s_mov_b64 exec, s[82:83]
  v_cvt_pk_bf16_f32 v42, v28, v29
  v_cvt_pk_bf16_f32 v43, v30, v31
  s_mov_b64 exec, -1
  s_cmp_eq_u32 s100, 0
  s_cbranch_scc1 MS_167
  buffer_store_dwordx2 v[42:43], v63, s[52:55], s80 offen
MSd_168:
  v_cvt_pk_bf16_f32 v44, v32, v33
W_X2_8:
  s_cbranch_execz W_X2_9
  v_cvt_pk_bf16_f32 v45, v34, v35
  s_mov_b64 exec, s[82:83]
  v_cvt_pk_bf16_f32 v44, v36, v37
  v_cvt_pk_bf16_f32 v45, v38, v39
  s_mov_b64 exec, -1
  s_cmp_eq_u32 s100, 0
  s_cbranch_scc1 MS_169
  buffer_store_dwordx2 v[44:45], v63, s[52:55], s81 offen
MSd_170:
  s_branch L_Y3
L_Y2:
  s_nop 3
  v_cvt_pk_bf16_f32 v40, v16, v17
  v_cvt_pk_bf16_f32 v41, v18, v19
  s_mov_b64 exec, s[82:83]
  v_cvt_pk_bf16_f32 v40, v20, v21
  v_cvt_pk_bf16_f32 v41, v22, v23
  s_mov_b64 exec, -1
  s_cmp_eq_u32 s100, 0
  s_cbranch_scc1 MS_171
  buffer_store_dwordx2 v[40:41], v63, s[52:55], 0 offen
MSd_172:
  v_cvt_pk_bf16_f32 v42, v24, v25
  v_cvt_pk_bf16_f32 v43, v26, v27
  s_mov_b64 exec, s[82:83]
  v_cvt_pk_bf16_f32 v42, v28, v29
  v_cvt_pk_bf16_f32 v43, v30, v31
  s_mov_b64 exec, -1
  s_cmp_eq_u32 s100, 0
  s_cbranch_scc1 MS_173
  buffer_store_dwordx2 v[42:43], v63, s[52:55], s80 offen
MSd_174:
L_Y3:
  s_barrier
L_T4B:
  s_cmp_ge_u32 s3, 5
  s_cbranch_scc1 L_END
  v_mov_b32 v218, 0
  v_mov_b32 v219, 0
  s_mov_b32 s10, 0xffbfffbf
  s_mov_b32 s7, 1048576
  buffer_load_dwordx2 v[212:213], v248, s[52:55], s6 offen offset:0 sc1
  buffer_load_dwordx2 v[214:215], v248, s[52:55], s6 offen offset:512 sc1
W_X2_9:
  s_cbranch_execz W_X2_10
  buffer_load_dwordx2 v[216:217], v248, s[52:55], s6 offen offset:1024 sc1
  s_mov_b64 exec, 0xffffff
  buffer_load_dwordx2 v[218:219], v248, s[52:55], s6 offen offset:1536 sc1
  s_mov_b64 exec, -1
SP_175:
  buffer_load_dwordx2 v[212:213], v248, s[52:55], s6 offen offset:0 sc1
  buffer_load_dwordx2 v[214:215], v248, s[52:55], s6 offen offset:512 sc1
  buffer_load_dwordx2 v[216:217], v248, s[52:55], s6 offen offset:1024 sc1
  s_mov_b64 exec, 0xffffff
  buffer_load_dwordx2 v[218:219], v248, s[52:55], s6 offen offset:1536 sc1
  s_mov_b64 exec, -1
  s_waitcnt vmcnt(4)
  v_max3_u32 v236, v212, v213, v214
  v_max3_u32 v237, v215, v216, v217
  v_max3_u32 v236, v236, v218, v219
  v_max_u32 v236, v236, v237
  v_cmp_le_u32 vcc, s10, v236
  s_cbranch_vccz SPok_176
  v_cmp_eq_u32 vcc, s10, v236
  s_cbranch_vccnz SPr_177
  s_mov_b64 s[12:13], 0
  v_cmp_eq_u32 vcc, s10, v212
  s_nop 0
  s_or_b64 s[12:13], s[12:13], vcc
  v_cmp_eq_u32 vcc, s10, v213
  s_nop 0
  s_or_b64 s[12:13], s[12:13], vcc
  v_cmp_eq_u32 vcc, s10, v214
  s_nop 0
  s_or_b64 s[12:13], s[12:13], vcc
  v_cmp_eq_u32 vcc, s10, v215
  s_nop 0
  s_or_b64 s[12:13], s[12:13], vcc
  v_cmp_eq_u32 vcc, s10, v216
  s_nop 0
  s_or_b64 s[12:13], s[12:13], vcc
  v_cmp_eq_u32 vcc, s10, v217
  s_nop 0
  s_or_b64 s[12:13], s[12:13], vcc
  v_cmp_eq_u32 vcc, s10, v218
  s_nop 0
  s_or_b64 s[12:13], s[12:13], vcc
  v_cmp_eq_u32 vcc, s10, v219
  s_nop 0
  s_or_b64 s[12:13], s[12:13], vcc
W_X2_10:
  s_cbranch_execz W_X2_11
  s_cmp_eq_u64 s[12:13], 0
  s_cbranch_scc1 SPok_176
SPr_177:
  s_sub_u32 s7, s7, 1
  s_cbranch_scc0 SP_175
  s_branch L_END
SPok_176:
  v_dot2_f32_bf16 v228, v212, v2, 0
  v_dot2_f32_bf16 v229, v212, v3, 0
  v_dot2_f32_bf16 v230, v213, v2, 0
  v_dot2_f32_bf16 v231, v213, v3, 0
  v_dot2_f32_bf16 v228, v214, v2, v228
  v_dot2_f32_bf16 v229, v214, v3, v229
  v_dot2_f32_bf16 v230, v215, v2, v230
  v_dot2_f32_bf16 v231, v215, v3, v231
  v_dot2_f32_bf16 v228, v216, v2, v228
  v_dot2_f32_bf16 v229, v216, v3, v229
  v_dot2_f32_bf16 v230, v217, v2, v230
  v_dot2_f32_bf16 v231, v217, v3, v231
  v_dot2_f32_bf16 v228, v218, v2, v228
  v_dot2_f32_bf16 v229, v218, v3, v229
  v_dot2_f32_bf16 v230, v219, v2, v230
  v_dot2_f32_bf16 v231, v219, v3, v231
  v_lshlrev_b32 v241, v252, v240
  v_and_b32 v241, 0xffff0000, v241
  v_permlane32_swap_b32 v228, v230
  v_permlane32_swap_b32 v229, v231
  v_pk_add_f32 v[228:229], v[228:229], v[230:231]
  s_nop 1
  v_permlane16_swap_b32 v228, v229
  v_add_f32 v228, v228, v229
  s_nop 1
  v_add_f32_dpp v228, v228, v228 row_ror:8 row_mask:0xf bank_mask:0xf
  v_fma_f32 v228, v249, v228, v241
  s_mov_b32 exec_lo, 0x00ff00ff
  s_mov_b32 exec_hi, 0x00ff00ff
W_X2_11:
  s_cbranch_execz W_X2_12
  v_cvt_pk_bf16_f32 v228, v228, v228
  buffer_store_short v228, v250, s[68:71], s42 offen
  s_mov_b64 exec, -1
W_X2_12:
  s_cbranch_execz L_WRET_X2
  s_branch L_END
L_T4:
  s_mov_b32 s10, 0xffbfffbf
  s_mov_b32 s7, 1048576
XP_178:
  buffer_load_dword v240, v251, s[52:55], s43 offen sc1
  s_waitcnt vmcnt(0)
  v_cmp_eq_u32 vcc, s10, v240
  s_cbranch_vccz L_T4B
  s_cmp_ge_u32 s3, 5
  s_cbranch_scc1 L_END
  s_sleep 2
  s_sub_u32 s7, s7, 1
  s_cbranch_scc0 XP_178
  s_branch L_END
L_END:
L_EXIT:
  s_endpgm
MS_85:
  s_nop 7
  buffer_store_dword v228, v255, s[52:55], s92 offen sc1
  s_branch MSd_86
MS_147:
  s_nop 7
  buffer_store_dwordx4 v[16:19], v7, s[52:55], s8 offen sc1
  s_branch MSd_148
MS_149:
  s_nop 7
  buffer_store_dwordx4 v[16:19], v7, s[52:55], s8 offen offset:1024 sc1
  s_branch MSd_150
MS_165:
  s_nop 7
  buffer_store_dwordx2 v[40:41], v63, s[52:55], 0 offen sc1
  s_branch MSd_166
MS_167:
  s_nop 7
  buffer_store_dwordx2 v[42:43], v63, s[52:55], s80 offen sc1
  s_branch MSd_168
MS_169:
  s_nop 7
  buffer_store_dwordx2 v[44:45], v63, s[52:55], s81 offen sc1
  s_branch MSd_170
MS_171:
  s_nop 7
  buffer_store_dwordx2 v[40:41], v63, s[52:55], 0 offen sc1
  s_branch MSd_172
MS_173:
  s_nop 7
  buffer_store_dwordx2 v[42:43], v63, s[52:55], s80 offen sc1
  s_branch MSd_174
L_WRET_Q:
  s_cmp_eq_u32 s60, 1
  s_cbranch_scc1 L_RET_Q1
  s_endpgm
L_WRET_G:
  s_cmp_eq_u32 s60, 1
  s_cbranch_scc1 L_RET_G1
  s_cmp_eq_u32 s60, 2
  s_cbranch_scc1 L_RET_G2
  s_endpgm
L_WRET_W:
  s_cmp_eq_u32 s60, 1
  s_cbranch_scc1 L_RET_W1
  s_endpgm
L_WRET_X1:
  s_cmp_eq_u32 s60, 1
  s_cbranch_scc1 L_RET_X11
  s_endpgm
L_WRET_X2:
  s_cmp_eq_u32 s60, 1
  s_cbranch_scc1 L_RET_X21
  s_endpgm
.section .rodata,"a"
.p2align 6
.amdhsa_kernel adaLN_cond__sliding_block_cached__dense_activation_silu__decode_kernel
  .amdhsa_next_free_vgpr 256
  .amdhsa_next_free_sgpr 102
  .amdhsa_accum_offset 256
  .amdhsa_group_segment_fixed_size 0
  .amdhsa_kernarg_size 104
  .amdhsa_user_sgpr_count 2
  .amdhsa_user_sgpr_kernarg_segment_ptr 1
  .amdhsa_system_sgpr_workgroup_id_x 1
  .amdhsa_float_denorm_mode_32 3
.end_amdhsa_kernel
```
